```python
import torch

def _softmax(x, axis=-1):
    return torch.softmax(x, dim=axis)
def _gelu(x):
    return torch.nn.functional.gelu(x, approximate="tanh")
def _silu(x):
    return torch.nn.functional.silu(x)
def _sigmoid(x):
    return torch.sigmoid(x)
def _layernorm(x, axis=-1, eps=1e-5):
    m = x.mean(dim=axis, keepdim=True)
    v = x.var(dim=axis, keepdim=True, unbiased=False)
    return (x - m) / torch.sqrt(v + eps)
def _scatter_add(tgt, idx, src, axis=0):
    return tgt.clone().index_add_(axis, idx, src)
def _segment_sum(src, seg, n):
    out = torch.zeros((n,) + src.shape[1:], dtype=src.dtype)
    return out.index_add_(0, seg, src)
def _pad(x, pw):
    flat = tuple(v for pair in reversed(pw) for v in pair)
    return torch.nn.functional.pad(x, flat)

kernel_name = 'sequential_preLN__sliding_block_cached__swiglu_ffn__decode'

def setup_inputs():

    _w = (lambda a: (lambda t: t.to(torch.bfloat16) if t.is_floating_point() else t)(torch.as_tensor(a)))
    def _A_setup():
        B, Sq, D = 1, 1, 512
        Hq, Hkv, Sk, Dh = 32, 32, 32768, 128
        assert Hq % Hkv == 0, (Hq, Hkv)
        return {
            "x": _w((lambda *s: torch.randn(*s, dtype=torch.bfloat16) * 0.05)(B, Sq, D)),
            "k_cache": _w((lambda *s: torch.randn(*s, dtype=torch.bfloat16) * 3.2)(B, Hkv, Sk, Dh)),
            "v_cache": _w((lambda *s: torch.randn(*s, dtype=torch.bfloat16) * 0.4)(B, Hkv, Sk, Dh)),
            "wq": _w((lambda *s: torch.randn(*s, dtype=torch.bfloat16) * 3.2)(D, Hq * Dh) * (D ** -0.5)),
            "wo": _w((lambda *s: torch.randn(*s, dtype=torch.bfloat16) * 0.4)(Hq * Dh, D) * ((Hq * Dh) ** -0.5)),
        }
    _A_in = _A_setup()

    def _B_setup():
        B, S, D, F = 1, 1, 512, 1376
        return {
            "x": _w((lambda *s: torch.randn(*s, dtype=torch.bfloat16) * 0.05)(B, S, D)),
            "w_gate": _w((lambda *s: torch.randn(*s, dtype=torch.bfloat16) * 0.05)(D, F)),
            "w_up": _w((lambda *s: torch.randn(*s, dtype=torch.bfloat16) * 0.05)(D, F)),
            "w_down": _w((lambda *s: torch.randn(*s, dtype=torch.bfloat16) * 0.05)(F, D)),
        }
    _B_in = _B_setup()

    return {
        "A_x": _A_in["x"],
        "A_k_cache": _A_in["k_cache"],
        "A_v_cache": _A_in["v_cache"],
        "A_wq": _A_in["wq"],
        "A_wo": _A_in["wo"],
        "B_x": _B_in["x"],
        "B_w_gate": _B_in["w_gate"],
        "B_w_up": _B_in["w_up"],
        "B_w_down": _B_in["w_down"],
    }

def reference(A_x, A_k_cache, A_v_cache, A_wq, A_wo, B_x, B_w_gate, B_w_up, B_w_down):
    def _A_ref(x, k_cache, v_cache, wq, wo):
        B, Sq, D = x.shape
        Hq, Dh = 32, 128
        Hkv, Sk = k_cache.shape[1], k_cache.shape[2]
        W = min(4096, max(256, Sk // 4))
        rep = Hq // Hkv
        q = (lambda x, *d: x.permute(*d))((x @ wq).reshape(B, Sq, Hq, Dh), 0, 2, 1, 3)
        k = (lambda x, n, axis: torch.repeat_interleave(x, n, dim=axis))(k_cache[:, :, Sk - W:, :], rep, axis=1)
        v = (lambda x, n, axis: torch.repeat_interleave(x, n, dim=axis))(v_cache[:, :, Sk - W:, :], rep, axis=1)
        scores = torch.einsum("bhqd,bhkd->bhqk", q, k) * (Dh ** -0.5)
        p = _softmax(scores, axis=-1)
        o = torch.einsum("bhqk,bhkd->bhqd", p, v)
        return (lambda x, *d: x.permute(*d))(o, 0, 2, 1, 3).reshape(B, Sq, Hq * Dh) @ wo

    def _B_ref(x, w_gate, w_up, w_down):
        g = _silu(x @ w_gate)
        u = x @ w_up
        return (g * u) @ w_down

    x = A_x
    h = x + _A_ref(_layernorm(x, axis=-1), A_k_cache, A_v_cache, A_wq, A_wo)
    h2 = h + _B_ref(_layernorm(h, axis=-1), B_w_gate, B_w_up, B_w_down)
    return h2
```

```asm
; @launch grid=(256,1,1) block=(512,1,1) lds=39936
.amdgcn_target "amdgcn-amd-amdhsa--gfx950"
.text
.globl sequential_preLN__sliding_block_cached__swiglu_ffn__decode_kernel
.p2align 12
.p2align 8
.type sequential_preLN__sliding_block_cached__swiglu_ffn__decode_kernel,@function
sequential_preLN__sliding_block_cached__swiglu_ffn__decode_kernel:
    s_load_dwordx16 s[4:19], s[0:1], 0
    s_load_dwordx8 s[20:27], s[0:1], 64
    s_getpc_b64 s[40:41]
L_pc:
    v_lshrrev_b32 v1, 6, v0
    s_lshr_b32 s30, s2, 3
    v_readfirstlane_b32 s28, v1
    v_and_b32 v0, 63, v0
    s_cmp_ge_u32 s2, 256
    s_cbranch_scc1 L_exit
    s_lshl3_add_u32 s43, s30, s28
    s_lshl_b32 s43, s43, 6
    v_mov_b32 v1, s43
    global_load_dword v1, v1, s[40:41]
    s_and_b32 s29, s2, 7
    s_and_b32 s31, s30, 3
    s_lshl2_add_u32 s31, s29, s31
    s_lshr_b32 s32, s30, 2
    v_lshrrev_b32 v3, 3, v0
    v_and_b32 v4, 7, v0
    v_lshlrev_b32 v4, 4, v4
    v_lshl_add_u32 v2, v3, 12, v4
    v_lshlrev_b32 v5, 4, v0
    s_and_b32 s63, s28, 3
    s_lshl2_add_u32 s33, s31, s32
    s_add_u32 s33, s33, s29
    s_and_b32 s33, s33, 15
    s_lshl_b32 s33, s33, 8
    s_lshl_b32 s34, s31, 6
    s_add_u32 s34, s34, s32
    s_add_u32 s34, s34, 56
    s_lshl2_add_u32 s34, s34, s63
    s_lshl_b32 s34, s34, 15
    s_mov_b32 s38, 0x8000
    s_mov_b32 s39, 0x20000
    s_cmp_lt_u32 s28, 4
    s_cbranch_scc1 L_kwave
    s_lshl_b32 s35, s32, 5
    s_add_u32 s35, s35, s63
    s_lshl_b32 s35, s35, 6
    s_add_u32 s35, s35, s31
    s_lshl_b32 s35, s35, 8
    v_lshl_add_u32 v6, v3, 16, v4
    v_add_u32 v12, 0x2000, v6
    v_subrev_u32 v13, 12, v0
    v_ashrrev_i32 v13, 31, v13
    v_lshlrev_b32 v14, 2, v0
    ds_write_b32 v14, v13 offset:6656
    s_and_b32 s51, s32, 1
    s_lshl3_add_u32 s51, s51, s28
    s_cmp_lg_u32 s51, 4
    s_cbranch_scc1 L_nosel
    s_mov_b32 s48, 0x222233f0
    s_mov_b32 s49, 0xfff84476
    s_lshr_b32 s50, s30, 3
    s_and_b32 s51, s30, 3
    s_lshl2_add_u32 s50, s50, s51
    s_lshl_b32 s50, s50, 2
    s_lshr_b64 s[48:49], s[48:49], s50
    s_and_b32 s48, s48, 15
    s_lshl_b32 m0, s48, 1
    s_cmp_eq_u32 s51, 3
    s_cselect_b32 s50, 0x200000, 0
    s_cmp_eq_u32 s48, 2
    s_cselect_b32 s50, s34, s50
    s_cmp_eq_u32 s48, 15
L_nosel:
    s_waitcnt lgkmcnt(0)
    s_cbranch_scc1 L_notouch
    s_movrels_b64 s[48:49], s[4:5]
    s_load_dword s51, s[48:49], s50
L_notouch:
    s_setprio 3
    global_load_dwordx4 v[24:27], v5, s[4:5]
    s_load_dword s3, s[26:27], 0x73000
    s_add_u32 s10, s10, s35
    s_addc_u32 s11, s11, 0
    global_load_dwordx4 v[64:67], v6, s[10:11] offset:0 nt
    global_load_dwordx4 v[68:71], v6, s[10:11] offset:128 nt
    global_load_dwordx4 v[72:75], v12, s[10:11] offset:0 nt
    global_load_dwordx4 v[76:79], v12, s[10:11] offset:128 nt
    s_barrier
    s_branch L_vwave
L_kwave:
    s_setprio 2
    s_waitcnt lgkmcnt(0)
    s_add_u32 s36, s6, s34
    s_addc_u32 s37, s7, 0
    buffer_load_dwordx4 v[128:131], v2, s[36:39], s33 offen offset:0 nt
    buffer_load_dwordx4 v[132:135], v2, s[36:39], s33 offen offset:128 nt
    s_barrier
    s_addk_i32 s33, 0x100
    s_bitset0_b32 s33, 12
    buffer_load_dwordx4 v[136:139], v2, s[36:39], s33 offen offset:0 nt
    buffer_load_dwordx4 v[140:143], v2, s[36:39], s33 offen offset:128 nt
    s_addk_i32 s33, 0x100
    s_bitset0_b32 s33, 12
    buffer_load_dwordx4 v[144:147], v2, s[36:39], s33 offen offset:0 nt
    buffer_load_dwordx4 v[148:151], v2, s[36:39], s33 offen offset:128 nt
    s_addk_i32 s33, 0x100
    s_bitset0_b32 s33, 12
    buffer_load_dwordx4 v[152:155], v2, s[36:39], s33 offen offset:0 nt
    buffer_load_dwordx4 v[156:159], v2, s[36:39], s33 offen offset:128 nt
    s_lshl_b32 s34, s31, 6
    s_add_u32 s34, s34, s28
    s_lshl_b32 s34, s34, 7
    s_add_u32 s44, s26, s34
    s_addc_u32 s45, s27, 0
    v_lshl_add_u32 v6, v3, 10, v4
    s_addk_i32 s33, 0x100
    s_bitset0_b32 s33, 12
    s_waitcnt vmcnt(6)
    buffer_load_dwordx4 v[160:163], v2, s[36:39], s33 offen offset:0 nt
    buffer_load_dwordx4 v[164:167], v2, s[36:39], s33 offen offset:128 nt
    s_addk_i32 s33, 0x100
    s_bitset0_b32 s33, 12
    s_waitcnt vmcnt(6)
    buffer_load_dwordx4 v[168:171], v2, s[36:39], s33 offen offset:0 nt
    buffer_load_dwordx4 v[172:175], v2, s[36:39], s33 offen offset:128 nt
    s_load_dword s3, s[26:27], 0x73000
    s_addk_i32 s33, 0x100
    s_bitset0_b32 s33, 12
    s_waitcnt vmcnt(6)
    buffer_load_dwordx4 v[176:179], v2, s[36:39], s33 offen offset:0 nt
    buffer_load_dwordx4 v[180:183], v2, s[36:39], s33 offen offset:128 nt
    s_addk_i32 s33, 0x100
    s_bitset0_b32 s33, 12
    s_waitcnt vmcnt(6)
    buffer_load_dwordx4 v[184:187], v2, s[36:39], s33 offen offset:0 nt
    buffer_load_dwordx4 v[188:191], v2, s[36:39], s33 offen offset:128 nt
    s_addk_i32 s33, 0x100
    s_bitset0_b32 s33, 12
    s_waitcnt vmcnt(6)
    buffer_load_dwordx4 v[192:195], v2, s[36:39], s33 offen offset:0 nt
    buffer_load_dwordx4 v[196:199], v2, s[36:39], s33 offen offset:128 nt
    s_addk_i32 s33, 0x100
    s_bitset0_b32 s33, 12
    s_waitcnt vmcnt(6)
    buffer_load_dwordx4 v[200:203], v2, s[36:39], s33 offen offset:0 nt
    buffer_load_dwordx4 v[204:207], v2, s[36:39], s33 offen offset:128 nt
    s_addk_i32 s33, 0x100
    s_bitset0_b32 s33, 12
    s_waitcnt vmcnt(6)
    buffer_load_dwordx4 v[208:211], v2, s[36:39], s33 offen offset:0 nt
    buffer_load_dwordx4 v[212:215], v2, s[36:39], s33 offen offset:128 nt
    s_addk_i32 s33, 0x100
    s_bitset0_b32 s33, 12
    s_waitcnt vmcnt(6)
    buffer_load_dwordx4 v[216:219], v2, s[36:39], s33 offen offset:0 nt
    buffer_load_dwordx4 v[220:223], v2, s[36:39], s33 offen offset:128 nt
    global_load_dwordx4 v[16:19], v6, s[44:45] sc1
    s_addk_i32 s33, 0x100
    s_bitset0_b32 s33, 12
    s_waitcnt vmcnt(7)
    buffer_load_dwordx4 v[224:227], v2, s[36:39], s33 offen offset:0 nt
    buffer_load_dwordx4 v[228:231], v2, s[36:39], s33 offen offset:128 nt
    s_addk_i32 s33, 0x100
    s_bitset0_b32 s33, 12
    s_waitcnt vmcnt(7)
    buffer_load_dwordx4 v[232:235], v2, s[36:39], s33 offen offset:0 nt
    buffer_load_dwordx4 v[236:239], v2, s[36:39], s33 offen offset:128 nt
    s_addk_i32 s33, 0x100
    s_bitset0_b32 s33, 12
    s_waitcnt vmcnt(7)
    buffer_load_dwordx4 v[240:243], v2, s[36:39], s33 offen offset:0 nt
    buffer_load_dwordx4 v[244:247], v2, s[36:39], s33 offen offset:128 nt
    s_addk_i32 s33, 0x100
    s_bitset0_b32 s33, 12
    s_waitcnt vmcnt(6)
    buffer_load_dwordx4 v[248:251], v2, s[36:39], s33 offen offset:0 nt
    buffer_load_dwordx4 v[252:255], v2, s[36:39], s33 offen offset:128 nt
    v_lshrrev_b32 v12, 5, v0
    v_and_b32 v13, 31, v0
    v_lshlrev_b32 v13, 4, v13
    s_and_b32 s34, s28, 1
    s_lshl_b32 s34, s34, 7
    s_and_b32 s35, s28, 2
    s_lshl1_add_u32 s34, s35, s34
    v_bfe_u32 v14, v0, 4, 1
    v_lshl_add_u32 v14, v12, 2, v14
    v_lshlrev_b32 v14, 1, v14
    v_add3_u32 v14, v14, v4, s34
    v_mov_b32 v24, 6656
    v_mov_b32 v25, 1
    s_lshl_b32 s34, s28, 2
    v_mov_b32 v26, s34
    s_waitcnt lgkmcnt(0)
    s_add_u32 s3, s3, 0x5bd1e3c7
    v_lshrrev_b32 v8, 1, v5
    v_xor_b32 v8, v8, v5
    v_bfe_u32 v8, v8, 4, 1
    v_lshlrev_b32 v8, 3, v8
    v_xor_b32 v8, s3, v8
    v_xor_b32 v8, 4, v8
    v_and_b32 v8, 15, v8
    s_waitcnt vmcnt(8)
    ds_write_b32 v26, v25 offset:6720
    s_mov_b32 s62, 262144
L_qchk:
    v_xor_b32 v20, v16, v8
    v_xor_b32 v21, v17, v8
    v_xor_b32 v22, v18, v8
    v_xor_b32 v23, v19, v8
    v_or3_b32 v15, v20, v21, v22
    v_bitop3_b32 v15, v15, v23, 15 bitop3:0xa8
    v_cmp_ne_u32 vcc, 0, v15
    s_nop 0
    s_cbranch_vccnz L_qagain
L_qok:
    v_permlane32_swap_b32 v20, v22
    v_permlane32_swap_b32 v21, v23
    v_add_f32 v20, v20, v22
    v_add_f32 v21, v21, v23
    s_nop 1
    v_permlane16_swap_b32 v20, v21
    v_add_f32 v20, v20, v21
    s_nop 1
    v_add_f32_dpp v20, v20, v20 row_ror:8 row_mask:0xf bank_mask:0xf
    v_cvt_pk_bf16_f32 v20, v20, v20
    ds_write_b16 v14, v20 offset:6912
    s_mov_b64 exec, 1
    s_waitcnt lgkmcnt(0)
    ds_add_u32 v24, v25 offset:52
    s_mov_b64 exec, -1
    s_mov_b32 s62, 262144
L_spin_1:
    ds_read_b32 v15, v24 offset:52
    s_waitcnt lgkmcnt(0)
    v_cmp_ne_u32 vcc, 4, v15
    s_nop 0
    s_cbranch_vccz L_spun_2
    s_sub_u32 s62, s62, 1
    s_cbranch_scc0 L_spin_1
L_spun_2:
    ds_read_b128 v[16:19], v4 offset:6912
    ds_read_b128 v[20:23], v4 offset:7040
    s_waitcnt lgkmcnt(0)
    v_dot2_f32_bf16 v32, v128, v16, 0
    v_dot2_f32_bf16 v33, v136, v16, 0
    v_dot2_f32_bf16 v34, v144, v16, 0
    v_dot2_f32_bf16 v35, v152, v16, 0
    v_dot2_f32_bf16 v32, v129, v17, v32
    v_dot2_f32_bf16 v33, v137, v17, v33
    v_dot2_f32_bf16 v34, v145, v17, v34
    v_dot2_f32_bf16 v35, v153, v17, v35
    v_dot2_f32_bf16 v32, v130, v18, v32
    v_dot2_f32_bf16 v33, v138, v18, v33
    v_dot2_f32_bf16 v34, v146, v18, v34
    v_dot2_f32_bf16 v35, v154, v18, v35
    v_dot2_f32_bf16 v32, v131, v19, v32
    v_dot2_f32_bf16 v33, v139, v19, v33
    v_dot2_f32_bf16 v34, v147, v19, v34
    v_dot2_f32_bf16 v35, v155, v19, v35
    v_dot2_f32_bf16 v32, v132, v20, v32
    v_dot2_f32_bf16 v33, v140, v20, v33
    v_dot2_f32_bf16 v34, v148, v20, v34
    v_dot2_f32_bf16 v35, v156, v20, v35
    v_dot2_f32_bf16 v32, v133, v21, v32
    v_dot2_f32_bf16 v33, v141, v21, v33
    v_dot2_f32_bf16 v34, v149, v21, v34
    v_dot2_f32_bf16 v35, v157, v21, v35
    v_dot2_f32_bf16 v32, v134, v22, v32
    v_dot2_f32_bf16 v33, v142, v22, v33
    v_dot2_f32_bf16 v34, v150, v22, v34
    v_dot2_f32_bf16 v35, v158, v22, v35
    v_dot2_f32_bf16 v32, v135, v23, v32
    v_dot2_f32_bf16 v33, v143, v23, v33
    v_dot2_f32_bf16 v34, v151, v23, v34
    v_dot2_f32_bf16 v35, v159, v23, v35
    v_dot2_f32_bf16 v36, v160, v16, 0
    v_dot2_f32_bf16 v37, v168, v16, 0
    v_dot2_f32_bf16 v38, v176, v16, 0
    v_dot2_f32_bf16 v39, v184, v16, 0
    v_dot2_f32_bf16 v36, v161, v17, v36
    v_dot2_f32_bf16 v37, v169, v17, v37
    v_dot2_f32_bf16 v38, v177, v17, v38
    v_dot2_f32_bf16 v39, v185, v17, v39
    v_dot2_f32_bf16 v36, v162, v18, v36
    v_dot2_f32_bf16 v37, v170, v18, v37
    v_dot2_f32_bf16 v38, v178, v18, v38
    v_dot2_f32_bf16 v39, v186, v18, v39
    v_dot2_f32_bf16 v36, v163, v19, v36
    v_dot2_f32_bf16 v37, v171, v19, v37
    v_dot2_f32_bf16 v38, v179, v19, v38
    v_dot2_f32_bf16 v39, v187, v19, v39
    v_dot2_f32_bf16 v36, v164, v20, v36
    v_dot2_f32_bf16 v37, v172, v20, v37
    v_dot2_f32_bf16 v38, v180, v20, v38
    v_dot2_f32_bf16 v39, v188, v20, v39
    v_dot2_f32_bf16 v36, v165, v21, v36
    v_dot2_f32_bf16 v37, v173, v21, v37
    v_dot2_f32_bf16 v38, v181, v21, v38
    v_dot2_f32_bf16 v39, v189, v21, v39
    v_dot2_f32_bf16 v36, v166, v22, v36
    v_dot2_f32_bf16 v37, v174, v22, v37
    v_dot2_f32_bf16 v38, v182, v22, v38
    v_dot2_f32_bf16 v39, v190, v22, v39
    v_dot2_f32_bf16 v36, v167, v23, v36
    v_dot2_f32_bf16 v37, v175, v23, v37
    v_dot2_f32_bf16 v38, v183, v23, v38
    v_dot2_f32_bf16 v39, v191, v23, v39
    v_dot2_f32_bf16 v40, v192, v16, 0
    v_dot2_f32_bf16 v41, v200, v16, 0
    v_dot2_f32_bf16 v42, v208, v16, 0
    v_dot2_f32_bf16 v43, v216, v16, 0
    v_dot2_f32_bf16 v40, v193, v17, v40
    v_dot2_f32_bf16 v41, v201, v17, v41
    v_dot2_f32_bf16 v42, v209, v17, v42
    v_dot2_f32_bf16 v43, v217, v17, v43
    v_dot2_f32_bf16 v40, v194, v18, v40
    v_dot2_f32_bf16 v41, v202, v18, v41
    v_dot2_f32_bf16 v42, v210, v18, v42
    v_dot2_f32_bf16 v43, v218, v18, v43
    v_dot2_f32_bf16 v40, v195, v19, v40
    v_dot2_f32_bf16 v41, v203, v19, v41
    v_dot2_f32_bf16 v42, v211, v19, v42
    v_dot2_f32_bf16 v43, v219, v19, v43
    v_dot2_f32_bf16 v40, v196, v20, v40
    v_dot2_f32_bf16 v41, v204, v20, v41
    v_dot2_f32_bf16 v42, v212, v20, v42
    v_dot2_f32_bf16 v43, v220, v20, v43
    v_dot2_f32_bf16 v40, v197, v21, v40
    v_dot2_f32_bf16 v41, v205, v21, v41
    v_dot2_f32_bf16 v42, v213, v21, v42
    v_dot2_f32_bf16 v43, v221, v21, v43
    v_dot2_f32_bf16 v40, v198, v22, v40
    v_dot2_f32_bf16 v41, v206, v22, v41
    v_dot2_f32_bf16 v42, v214, v22, v42
    v_dot2_f32_bf16 v43, v222, v22, v43
    v_dot2_f32_bf16 v40, v199, v23, v40
    v_dot2_f32_bf16 v41, v207, v23, v41
    v_dot2_f32_bf16 v42, v215, v23, v42
    v_dot2_f32_bf16 v43, v223, v23, v43
    s_waitcnt vmcnt(0)
    v_dot2_f32_bf16 v44, v224, v16, 0
    v_dot2_f32_bf16 v45, v232, v16, 0
    v_dot2_f32_bf16 v46, v240, v16, 0
    v_dot2_f32_bf16 v47, v248, v16, 0
    v_dot2_f32_bf16 v44, v225, v17, v44
    v_dot2_f32_bf16 v45, v233, v17, v45
    v_dot2_f32_bf16 v46, v241, v17, v46
    v_dot2_f32_bf16 v47, v249, v17, v47
    v_dot2_f32_bf16 v44, v226, v18, v44
    v_dot2_f32_bf16 v45, v234, v18, v45
    v_dot2_f32_bf16 v46, v242, v18, v46
    v_dot2_f32_bf16 v47, v250, v18, v47
    v_dot2_f32_bf16 v44, v227, v19, v44
    v_dot2_f32_bf16 v45, v235, v19, v45
    v_dot2_f32_bf16 v46, v243, v19, v46
    v_dot2_f32_bf16 v47, v251, v19, v47
    v_dot2_f32_bf16 v44, v228, v20, v44
    v_dot2_f32_bf16 v45, v236, v20, v45
    v_dot2_f32_bf16 v46, v244, v20, v46
    v_dot2_f32_bf16 v47, v252, v20, v47
    v_dot2_f32_bf16 v44, v229, v21, v44
    v_dot2_f32_bf16 v45, v237, v21, v45
    v_dot2_f32_bf16 v46, v245, v21, v46
    v_dot2_f32_bf16 v47, v253, v21, v47
    v_dot2_f32_bf16 v44, v230, v22, v44
    v_dot2_f32_bf16 v45, v238, v22, v45
    v_dot2_f32_bf16 v46, v246, v22, v46
    v_dot2_f32_bf16 v47, v254, v22, v47
    v_dot2_f32_bf16 v44, v231, v23, v44
    v_dot2_f32_bf16 v45, v239, v23, v45
    v_dot2_f32_bf16 v46, v247, v23, v46
    v_dot2_f32_bf16 v47, v255, v23, v47
    v_add_f32_dpp v32, v32, v32 row_half_mirror row_mask:0xf bank_mask:0x5
    v_add_f32_dpp v33, v33, v33 row_half_mirror row_mask:0xf bank_mask:0x5
    v_add_f32_dpp v34, v34, v34 row_half_mirror row_mask:0xf bank_mask:0x5
    v_add_f32_dpp v35, v35, v35 row_half_mirror row_mask:0xf bank_mask:0x5
    v_add_f32_dpp v36, v36, v36 row_half_mirror row_mask:0xf bank_mask:0x5
    v_add_f32_dpp v37, v37, v37 row_half_mirror row_mask:0xf bank_mask:0x5
    v_add_f32_dpp v38, v38, v38 row_half_mirror row_mask:0xf bank_mask:0x5
    v_add_f32_dpp v39, v39, v39 row_half_mirror row_mask:0xf bank_mask:0x5
    v_add_f32_dpp v32, v40, v40 row_half_mirror row_mask:0xf bank_mask:0xa
    v_add_f32_dpp v33, v41, v41 row_half_mirror row_mask:0xf bank_mask:0xa
    v_add_f32_dpp v34, v42, v42 row_half_mirror row_mask:0xf bank_mask:0xa
    v_add_f32_dpp v35, v43, v43 row_half_mirror row_mask:0xf bank_mask:0xa
    v_add_f32_dpp v36, v44, v44 row_half_mirror row_mask:0xf bank_mask:0xa
    v_add_f32_dpp v37, v45, v45 row_half_mirror row_mask:0xf bank_mask:0xa
    v_add_f32_dpp v38, v46, v46 row_half_mirror row_mask:0xf bank_mask:0xa
    v_add_f32_dpp v39, v47, v47 row_half_mirror row_mask:0xf bank_mask:0xa
    s_mov_b32 vcc_lo, 0xcccccccc
    s_mov_b32 vcc_hi, 0xcccccccc
    v_cndmask_b32 v40, v36, v32, vcc
    v_cndmask_b32 v32, v32, v36, vcc
    v_cndmask_b32 v41, v37, v33, vcc
    v_cndmask_b32 v33, v33, v37, vcc
    v_cndmask_b32 v42, v38, v34, vcc
    v_cndmask_b32 v34, v34, v38, vcc
    v_cndmask_b32 v43, v39, v35, vcc
    v_cndmask_b32 v35, v35, v39, vcc
    v_add_f32_dpp v32, v40, v32 quad_perm:[2,3,0,1] row_mask:0xf bank_mask:0xf
    v_add_f32_dpp v33, v41, v33 quad_perm:[2,3,0,1] row_mask:0xf bank_mask:0xf
    v_add_f32_dpp v34, v42, v34 quad_perm:[2,3,0,1] row_mask:0xf bank_mask:0xf
    v_add_f32_dpp v35, v43, v35 quad_perm:[2,3,0,1] row_mask:0xf bank_mask:0xf
    s_mov_b32 vcc_lo, 0xaaaaaaaa
    s_mov_b32 vcc_hi, 0xaaaaaaaa
    v_cndmask_b32 v40, v34, v32, vcc
    v_cndmask_b32 v32, v32, v34, vcc
    v_cndmask_b32 v41, v35, v33, vcc
    v_cndmask_b32 v33, v33, v35, vcc
    v_add_f32_dpp v32, v40, v32 quad_perm:[1,0,3,2] row_mask:0xf bank_mask:0xf
    s_nop 0
    v_add_f32_dpp v33, v41, v33 quad_perm:[1,0,3,2] row_mask:0xf bank_mask:0xf
    v_cvt_pk_bf16_f32 v34, v32, v33
    v_lshlrev_b32 v32, 16, v34
    v_and_b32 v33, 0xffff0000, v34
    v_mul_f32 v32, 0x3db504f3, v32
    v_mul_f32 v33, 0x3db504f3, v33
    v_cvt_pk_bf16_f32 v34, v32, v33
    v_lshlrev_b32 v32, 16, v34
    v_and_b32 v33, 0xffff0000, v34
    v_max_f32 v34, v32, v33
    s_nop 1
    v_max_f32_dpp v34, v34, v34 row_ror:8 row_mask:0xf bank_mask:0xf
    s_nop 1
    v_max_f32_dpp v34, v34, v34 row_ror:4 row_mask:0xf bank_mask:0xf
    s_nop 1
    v_max_f32_dpp v34, v34, v34 row_ror:2 row_mask:0xf bank_mask:0xf
    s_nop 1
    v_max_f32_dpp v34, v34, v34 row_ror:1 row_mask:0xf bank_mask:0xf
    v_mov_b32 v36, v34
    s_nop 1
    v_permlane16_swap_b32 v34, v36
    v_max_f32 v34, v34, v36
    v_mov_b32 v36, v34
    s_nop 1
    v_permlane32_swap_b32 v34, v36
    v_max_f32 v34, v34, v36
    v_sub_f32 v35, v32, v34
    v_sub_f32 v36, v33, v34
    v_mul_f32 v35, 0x3fb8aa3b, v35
    v_mul_f32 v36, 0x3fb8aa3b, v36
    v_exp_f32 v35, v35
    v_exp_f32 v36, v36
    s_nop 0
    v_add_f32 v35, v35, v36
    s_nop 1
    v_add_f32_dpp v35, v35, v35 row_ror:8 row_mask:0xf bank_mask:0xf
    s_nop 1
    v_add_f32_dpp v35, v35, v35 row_ror:4 row_mask:0xf bank_mask:0xf
    s_nop 1
    v_add_f32_dpp v35, v35, v35 row_ror:2 row_mask:0xf bank_mask:0xf
    s_nop 1
    v_add_f32_dpp v35, v35, v35 row_ror:1 row_mask:0xf bank_mask:0xf
    v_mov_b32 v36, v35
    s_nop 1
    v_permlane16_swap_b32 v35, v36
    v_add_f32 v35, v35, v36
    v_mov_b32 v36, v35
    s_nop 1
    v_permlane32_swap_b32 v35, v36
    v_add_f32 v35, v35, v36
    s_lshl_b32 s34, s29, 8
    s_add_u32 s34, s34, 466944
    v_lshrrev_b32 v10, 2, v13
    v_add_u32 v10, s34, v10
    global_load_dword v9, v10, s[26:27] sc1
    v_min_u32 v34, -2, v34
    v_min_u32 v35, -2, v35
    v_lshl_add_u32 v37, v26, 1, v24
    ds_write_b64 v37, v[34:35]
    s_cmp_lg_u32 s28, 0
    s_cbranch_scc1 L_mlwait
    s_mov_b32 s62, 262144
L_spin_3:
    ds_read_b128 v[40:43], v24
    ds_read_b128 v[44:47], v24 offset:16
    s_waitcnt lgkmcnt(0)
    v_max3_u32 v37, v40, v41, v42
    v_max3_u32 v37, v37, v43, v44
    v_max3_u32 v37, v37, v45, v46
    v_max_u32 v37, v37, v47
    v_cmp_eq_u32 vcc, -1, v37
    s_nop 0
    s_cbranch_vccz L_spun_4
    s_sub_u32 s62, s62, 1
    s_cbranch_scc0 L_spin_3
L_spun_4:
    s_lshl_b32 s35, s31, 8
    s_add_u32 s35, s35, 458752
    v_max3_f32 v48, v40, v42, v44
    v_max_f32 v48, v48, v46
    v_sub_f32 v40, v40, v48
    v_sub_f32 v42, v42, v48
    v_sub_f32 v44, v44, v48
    v_sub_f32 v46, v46, v48
    v_mul_f32 v40, 0x3fb8aa3b, v40
    v_mul_f32 v42, 0x3fb8aa3b, v42
    v_mul_f32 v44, 0x3fb8aa3b, v44
    v_mul_f32 v46, 0x3fb8aa3b, v46
    v_exp_f32 v40, v40
    v_exp_f32 v42, v42
    v_exp_f32 v44, v44
    v_exp_f32 v46, v46
    v_mov_b32 v49, s3
    v_mov_b32 v51, s3
    v_mul_f32 v50, v40, v41
    v_fmac_f32 v50, v42, v43
    v_fmac_f32 v50, v44, v45
    v_fmac_f32 v50, v46, v47
    s_lshl4_add_u32 s34, s32, s35
    v_mov_b32 v37, s34
    s_mov_b64 exec, 1
    global_store_dwordx4 v37, v[48:51], s[26:27] sc1
    s_mov_b64 exec, -1
    s_mov_b32 s62, 262144
L_ml:
    s_sleep 2
    s_load_dwordx16 s[64:79], s[26:27], s35 glc
    s_load_dwordx16 s[80:95], s[26:27], s35 offset:64 glc
    s_waitcnt lgkmcnt(0)
    s_and_b32 s34, s65, s3
    s_or_b32 s47, s65, s3
    s_and_b32 s34, s34, s67
    s_or_b32 s47, s47, s67
    s_and_b32 s34, s34, s69
    s_or_b32 s47, s47, s69
    s_and_b32 s34, s34, s71
    s_or_b32 s47, s47, s71
    s_and_b32 s34, s34, s73
    s_or_b32 s47, s47, s73
    s_and_b32 s34, s34, s75
    s_or_b32 s47, s47, s75
    s_and_b32 s34, s34, s77
    s_or_b32 s47, s47, s77
    s_and_b32 s34, s34, s79
    s_or_b32 s47, s47, s79
    s_and_b32 s34, s34, s81
    s_or_b32 s47, s47, s81
    s_and_b32 s34, s34, s83
    s_or_b32 s47, s47, s83
    s_and_b32 s34, s34, s85
    s_or_b32 s47, s47, s85
    s_and_b32 s34, s34, s87
    s_or_b32 s47, s47, s87
    s_and_b32 s34, s34, s89
    s_or_b32 s47, s47, s89
    s_and_b32 s34, s34, s91
    s_or_b32 s47, s47, s91
    s_and_b32 s34, s34, s93
    s_or_b32 s47, s47, s93
    s_and_b32 s34, s34, s95
    s_or_b32 s47, s47, s95
    s_cmp_eq_u32 s34, s47
    s_cbranch_scc1 L_mlgot
    s_sub_u32 s62, s62, 1
    s_cbranch_scc0 L_ml
L_mlgot:
    v_mov_b32 v34, s64
    v_max_f32 v34, s68, v34
    v_max_f32 v34, s72, v34
    v_max_f32 v34, s76, v34
    v_max_f32 v34, s80, v34
    v_max_f32 v34, s84, v34
    v_max_f32 v34, s88, v34
    v_max_f32 v34, s92, v34
    v_sub_f32 v40, s64, v34
    v_sub_f32 v41, s68, v34
    v_sub_f32 v42, s72, v34
    v_sub_f32 v43, s76, v34
    v_sub_f32 v44, s80, v34
    v_sub_f32 v45, s84, v34
    v_sub_f32 v46, s88, v34
    v_sub_f32 v47, s92, v34
    v_mul_f32 v40, 0x3fb8aa3b, v40
    v_mul_f32 v41, 0x3fb8aa3b, v41
    v_mul_f32 v42, 0x3fb8aa3b, v42
    v_mul_f32 v43, 0x3fb8aa3b, v43
    v_mul_f32 v44, 0x3fb8aa3b, v44
    v_mul_f32 v45, 0x3fb8aa3b, v45
    v_mul_f32 v46, 0x3fb8aa3b, v46
    v_mul_f32 v47, 0x3fb8aa3b, v47
    v_exp_f32 v40, v40
    v_exp_f32 v41, v41
    v_exp_f32 v42, v42
    v_exp_f32 v43, v43
    v_exp_f32 v44, v44
    v_exp_f32 v45, v45
    v_exp_f32 v46, v46
    v_exp_f32 v47, v47
    v_mul_f32 v35, s66, v40
    v_fmac_f32 v35, s70, v41
    v_fmac_f32 v35, s74, v42
    v_fmac_f32 v35, s78, v43
    v_fmac_f32 v35, s82, v44
    v_fmac_f32 v35, s86, v45
    v_fmac_f32 v35, s90, v46
    v_fmac_f32 v35, s94, v47
    v_rcp_f32 v35, v35
    v_min_u32 v34, -2, v34
    v_min_u32 v35, -2, v35
    ds_write_b64 v24, v[34:35] offset:32
    s_branch L_mlok
L_mlwait:
    s_mov_b32 s62, 262144
L_spin_5:
    s_sleep 1
    ds_read_b64 v[34:35], v24 offset:32
    s_waitcnt lgkmcnt(0)
    v_max_u32 v37, v34, v35
    v_cmp_eq_u32 vcc, -1, v37
    s_nop 0
    s_cbranch_vccz L_spun_6
    s_sub_u32 s62, s62, 1
    s_cbranch_scc0 L_spin_5
L_spun_6:
L_mlok:
    v_sub_f32 v32, v32, v34
    v_sub_f32 v33, v33, v34
    v_mul_f32 v32, 0x3fb8aa3b, v32
    v_mul_f32 v33, 0x3fb8aa3b, v33
    v_exp_f32 v32, v32
    v_exp_f32 v33, v33
    s_lshl_b32 s34, s28, 8
    v_lshl_add_u32 v36, v0, 2, s34
    v_mul_f32 v32, v32, v35
    v_mul_f32 v33, v33, v35
    v_cvt_pk_bf16_f32 v32, v32, v33
    ds_write_b32 v36, v32 offset:0
    s_getreg_b32 s34, hwreg(HW_REG_XCC_ID, 0, 4)
    s_andn2_b32 s35, s3, 31
    s_or_b32 s34, s34, s35
    s_or_b32 s35, s34, 16
    s_waitcnt vmcnt(0)
    v_cmp_eq_u32 s[48:49], s34, v9
    v_cmp_eq_u32 s[50:51], s35, v9
    s_bcnt1_i32_b32 s48, s48
    s_bcnt1_i32_b32 s50, s50
    s_cmp_gt_u32 s50, s48
    s_cselect_b32 s34, 0x2000, 0
    v_mov_b32 v10, s34
    v_lshrrev_b32 v8, 1, v5
    v_xor_b32 v8, v8, v5
    v_bfe_u32 v8, v8, 4, 1
    v_lshlrev_b32 v8, 7, v8
    v_xor_b32 v8, s3, v8
    v_and_b32 v8, 255, v8
    v_mov_b32 v11, 0xff
    s_lshl_b32 s47, s28, 13
    s_add_u32 s47, s47, 7168
    v_lshrrev_b32 v14, 4, v0
    s_lshr_b32 s34, s30, 1
    s_and_b32 s35, s30, 1
    s_lshl4_add_u32 s30, s35, s34
    s_waitcnt lgkmcnt(0)
    s_cmp_ge_u32 s30, 16
    s_cbranch_scc1 L_notw
    s_lshl2_add_u32 s34, s29, s28
    s_lshl_b32 s35, s34, 13
    s_add_u32 s44, s26, s35
    s_addc_u32 s45, s27, 0
    v_lshl_add_u32 v6, v12, 12, v13
    s_lshl_b32 s34, s34, 17
    s_lshl_b32 s35, s30, 6
    s_add_u32 s34, s34, s35
    s_add_u32 s40, s12, s34
    s_addc_u32 s41, s13, 0
    s_mov_b32 s42, 130112
    s_mov_b32 s43, 0x20000
    v_and_b32 v32, 1, v14
    v_bfe_u32 v15, v0, 3, 1
    v_lshl_add_u32 v15, v15, 2, v14
    v_bfe_u32 v33, v0, 2, 1
    v_lshl_add_u32 v15, v15, 1, v33
    v_lshlrev_b32 v33, 1, v32
    v_and_b32 v34, 3, v0
    v_xor_b32 v33, v33, v34
    v_lshlrev_b32 v33, 4, v33
    v_lshl_add_u32 v15, v15, 10, v33
    v_lshrrev_b32 v33, 2, v0
    v_lshlrev_b32 v33, 6, v33
    v_lshl_add_u32 v33, v34, 3, v33
    v_lshl_add_u32 v33, v32, 5, v33
    v_add_u32 v33, s47, v33
    v_xor_b32 v34, 32, v33
    v_add_u32 v37, v26, v13
    v_add_u32 v37, 6144, v37
    s_and_b32 s34, s29, 4
    s_add_u32 s34, s34, s29
    s_lshl4_add_u32 s34, s34, s30
    s_lshl_b32 s34, s34, 7
    s_add_u32 s34, s34, 262144
    s_add_u32 s56, s26, 0x8000
    s_addc_u32 s57, s27, 0
    s_add_u32 s58, s26, 0x10000
    s_addc_u32 s59, s27, 0
    s_add_u32 s68, s26, 0x18000
    s_addc_u32 s69, s27, 0
    v_lshrrev_b32 v38, 2, v13
    v_lshl_add_u32 v38, v12, 13, v38
    v_add_u32 v38, s34, v38
    v_lshrrev_b32 v9, 1, v38
    v_xor_b32 v9, v9, v38
    v_bfe_u32 v9, v9, 4, 1
    v_lshlrev_b32 v9, 7, v9
    v_xor_b32 v9, s3, v9
    v_and_b32 v9, 255, v9
    v_and_b32 v10, 15, v38
    v_cmp_eq_u32 vcc, 0, v10
    s_nop 1
    v_cndmask_b32 v10, 0, v11, vcc
    s_and_b32 s60, s30, 1
    s_lshl_b32 s61, s60, 16
    s_lshl_b32 s60, s60, 7
    v_xor_b32 v6, s60, v6
    s_mul_i32 s34, s30, 11264
    s_mul_i32 s35, s29, 180224
    s_add_u32 s34, s34, s35
    v_lshl_add_u32 v35, v0, 7, s34
    v_add_u32 v36, 0x2000, v35
    v_min_u32 v35, 1409020, v35
    v_min_u32 v36, 1409020, v36
    s_barrier
    s_barrier
    s_add_u32 m0, s47, 0
    s_xor_b32 s34, s61, 0
    buffer_load_dwordx4 v15, s[40:43], s34 offen lds
    s_add_u32 m0, s47, 1024
    s_xor_b32 s34, s61, 16384
    buffer_load_dwordx4 v15, s[40:43], s34 offen lds
    s_barrier
    s_add_u32 m0, s47, 2048
    s_xor_b32 s34, s61, 32768
    buffer_load_dwordx4 v15, s[40:43], s34 offen lds
    s_add_u32 m0, s47, 3072
    s_xor_b32 s34, s61, 49152
    buffer_load_dwordx4 v15, s[40:43], s34 offen lds
    s_add_u32 m0, s47, 4096
    s_xor_b32 s34, s61, 65536
    buffer_load_dwordx4 v15, s[40:43], s34 offen lds
    s_add_u32 m0, s47, 5120
    s_xor_b32 s34, s61, 81920
    buffer_load_dwordx4 v15, s[40:43], s34 offen lds
    s_add_u32 m0, s47, 6144
    s_xor_b32 s34, s61, 98304
    buffer_load_dwordx4 v15, s[40:43], s34 offen lds
    s_add_u32 m0, s47, 7168
    s_xor_b32 s34, s61, 114688
    buffer_load_dwordx4 v15, s[40:43], s34 offen lds
    global_load_dwordx4 v[96:99], v6, s[44:45] offset:0 sc1
    global_load_dwordx4 v[100:103], v6, s[44:45] offset:1024 sc1
    global_load_dwordx4 v[104:107], v6, s[44:45] offset:2048 sc1
    global_load_dwordx4 v[108:111], v6, s[44:45] offset:3072 sc1
    s_waitcnt vmcnt(10)
    ds_read_b64_tr_b16 v[128:129], v33 offset:0
    ds_read_b64_tr_b16 v[130:131], v33 offset:1024
    ds_read_b64_tr_b16 v[132:133], v34 offset:0
    ds_read_b64_tr_b16 v[134:135], v34 offset:1024
    s_waitcnt vmcnt(8)
    ds_read_b64_tr_b16 v[136:137], v33 offset:2048
    ds_read_b64_tr_b16 v[138:139], v33 offset:3072
    ds_read_b64_tr_b16 v[140:141], v34 offset:2048
    ds_read_b64_tr_b16 v[142:143], v34 offset:3072
    s_waitcnt vmcnt(6)
    ds_read_b64_tr_b16 v[144:145], v33 offset:4096
    ds_read_b64_tr_b16 v[146:147], v33 offset:5120
    ds_read_b64_tr_b16 v[148:149], v34 offset:4096
    ds_read_b64_tr_b16 v[150:151], v34 offset:5120
    s_waitcnt vmcnt(4)
    ds_read_b64_tr_b16 v[152:153], v33 offset:6144
    ds_read_b64_tr_b16 v[154:155], v33 offset:7168
    ds_read_b64_tr_b16 v[156:157], v34 offset:6144
    ds_read_b64_tr_b16 v[158:159], v34 offset:7168
    s_mov_b32 s62, 262144
    s_branch L_chk_8
L_again_7:
    global_load_dwordx4 v[96:99], v6, s[44:45] offset:0 sc1
    global_load_dwordx4 v[100:103], v6, s[44:45] offset:1024 sc1
    global_load_dwordx4 v[104:107], v6, s[44:45] offset:2048 sc1
    global_load_dwordx4 v[108:111], v6, s[44:45] offset:3072 sc1
    s_sub_u32 s62, s62, 1
    s_cbranch_scc1 L_ok_9
L_chk_8:
    s_waitcnt vmcnt(2)
    v_xor_b32 v120, v96, v8
    v_xor_b32 v121, v100, v8
    v_or_b32 v39, v120, v121
    v_pk_add_f32 v[18:19], v[98:99], v[102:103]
    v_add_f32 v16, v120, v121
    v_add_f32 v17, v97, v101
    s_waitcnt vmcnt(0)
    v_xor_b32 v122, v104, v8
    v_xor_b32 v123, v108, v8
    v_or_b32 v39, v39, v122
    v_bitop3_b32 v39, v39, v123, v11 bitop3:0xa8
    v_cmp_ne_u32 vcc, 0, v39
    v_pk_add_f32 v[22:23], v[106:107], v[110:111]
    s_cbranch_vccnz L_again_7
L_ok_9:
    v_add_f32 v20, v122, v123
    v_add_f32 v21, v105, v109
    v_pk_add_f32 v[18:19], v[18:19], v[22:23]
    v_pk_add_f32 v[16:17], v[16:17], v[20:21]
    s_nop 1
    v_permlane32_swap_b32 v16, v18
    v_permlane32_swap_b32 v17, v19
    v_pk_add_f32 v[16:17], v[16:17], v[18:19]
    v_cvt_pk_bf16_f32 v16, v16, v17
    s_waitcnt lgkmcnt(0)
    s_nop 0
    v_mov_b32_dpp v64, v16 row_newbcast:0 row_mask:0xf bank_mask:0xf
    v_mov_b32_dpp v65, v16 row_newbcast:1 row_mask:0xf bank_mask:0xf
    v_mov_b32_dpp v66, v16 row_newbcast:2 row_mask:0xf bank_mask:0xf
    v_mov_b32_dpp v67, v16 row_newbcast:3 row_mask:0xf bank_mask:0xf
    v_mov_b32_dpp v68, v16 row_newbcast:4 row_mask:0xf bank_mask:0xf
    v_mov_b32_dpp v69, v16 row_newbcast:5 row_mask:0xf bank_mask:0xf
    v_mfma_f32_16x16x32_bf16 v[40:43], v[64:67], v[128:131], 0
    v_mov_b32_dpp v70, v16 row_newbcast:6 row_mask:0xf bank_mask:0xf
    v_mov_b32_dpp v71, v16 row_newbcast:7 row_mask:0xf bank_mask:0xf
    v_mfma_f32_16x16x32_bf16 v[44:47], v[64:67], v[132:135], 0
    v_mov_b32_dpp v72, v16 row_newbcast:8 row_mask:0xf bank_mask:0xf
    v_mov_b32_dpp v73, v16 row_newbcast:9 row_mask:0xf bank_mask:0xf
    v_mfma_f32_16x16x32_bf16 v[40:43], v[68:71], v[136:139], v[40:43]
    v_mov_b32_dpp v74, v16 row_newbcast:10 row_mask:0xf bank_mask:0xf
    v_mov_b32_dpp v75, v16 row_newbcast:11 row_mask:0xf bank_mask:0xf
    v_mfma_f32_16x16x32_bf16 v[44:47], v[68:71], v[140:143], v[44:47]
    v_mov_b32_dpp v76, v16 row_newbcast:12 row_mask:0xf bank_mask:0xf
    v_mov_b32_dpp v77, v16 row_newbcast:13 row_mask:0xf bank_mask:0xf
    v_mfma_f32_16x16x32_bf16 v[40:43], v[72:75], v[144:147], v[40:43]
    v_mov_b32_dpp v78, v16 row_newbcast:14 row_mask:0xf bank_mask:0xf
    v_mov_b32_dpp v79, v16 row_newbcast:15 row_mask:0xf bank_mask:0xf
    v_mfma_f32_16x16x32_bf16 v[44:47], v[72:75], v[148:151], v[44:47]
    s_nop 0
    v_mfma_f32_16x16x32_bf16 v[40:43], v[76:79], v[152:155], v[40:43]
    v_mfma_f32_16x16x32_bf16 v[44:47], v[76:79], v[156:159], v[44:47]
    s_mov_b64 exec, 0xffff
    s_nop 6
    ds_write2_b32 v37, v40, v44 offset0:0 offset1:64
    s_mov_b64 exec, 1
    ds_add_u32 v24, v25 offset:96
    s_mov_b64 exec, -1
    ds_read_b32 v20, v24 offset:96
    ds_read_b128 v[16:19], v13 offset:6144
    s_waitcnt lgkmcnt(1)
    v_cmp_eq_u32 vcc, 4, v20
    s_waitcnt lgkmcnt(0)
    v_pk_add_f32 v[16:17], v[16:17], v[18:19]
    s_cbranch_vccz L_wend
    v_add_f32 v16, v16, v17
    v_bfi_b32 v16, v10, v9, v16
    global_store_dword v38, v16, s[26:27] sc1
    global_store_dword v38, v16, s[56:57] sc1
    global_store_dword v38, v16, s[58:59] sc1
    global_store_dword v38, v16, s[68:69] sc1
    global_load_dword v62, v35, s[20:21]
    s_mov_b64 exec, 0xffffff
    global_load_dword v62, v36, s[20:21]
L_wend:
    s_endpgm
L_qagain:
    global_load_dwordx4 v[16:19], v6, s[44:45] sc1
    s_sub_u32 s62, s62, 1
    s_waitcnt vmcnt(0)
    s_cbranch_scc0 L_qchk
    s_branch L_qok
L_notw:
    s_and_b32 s34, s30, 15
    s_lshl2_add_u32 s34, s34, s28
    s_andn2_b32 s35, s34, 7
    s_add_u32 s35, s35, s34
    s_add_u32 s35, s35, 8
    s_lshl_b32 s64, s29, 7
    s_add_u32 s35, s35, s64
    s_lshl_b32 s35, s35, 12
    v_lshl_add_u32 v127, v0, 7, s35
    s_lshr_b32 s34, s34, 1
    s_lshl_b32 s34, s34, 4
    v_lshrrev_b32 v61, 2, v0
    v_add_u32 v61, s34, v61
    v_mul_u32_u24 v61, 2752, v61
    v_and_b32 v15, 3, v0
    v_lshlrev_b32 v62, 7, v15
    v_min_u32 v62, 348, v62
    s_mul_i32 s34, s29, 352
    v_add3_u32 v61, v61, v62, s34
    s_bitcmp1_b32 s28, 0
    s_cselect_b32 s64, s18, s16
    s_cselect_b32 s65, s19, s17
    s_mov_b32 s66, 1409024
    s_mov_b32 s67, 0x20000
    s_cmp_lt_u32 s30, 27
    s_cbranch_scc1 L_rolef
    s_cmp_lt_u32 s30, 28
    s_cbranch_scc1 L_norole
    s_cmp_lg_u32 s28, 0
    s_cbranch_scc1 L_norole
    s_load_dword s48, s[22:23], 0 glc
    s_lshl2_add_u32 s63, s29, s30
    s_sub_u32 s63, s63, 28
    s_lshr_b32 s34, s63, 1
    s_xor_b32 s34, s34, s63
    s_and_b32 s34, s34, 2
    s_mul_i32 s34, s34, 3
    s_xor_b32 s63, s63, s34
    s_lshl_b32 s34, s63, 6
    s_add_u32 s34, s34, 524288
    v_lshrrev_b32 v44, 2, v0
    v_and_b32 v45, 12, v44
    v_add_u32 v44, v44, v45
    v_lshl_add_u32 v44, v44, 11, v10
    v_lshl_add_u32 v44, v15, 4, v44
    v_add_u32 v44, s34, v44
    v_add_u32 v45, 65536, v44
    v_add_u32 v46, 131072, v44
    v_add_u32 v47, 196608, v44
    v_add_u32 v48, 262144, v44
    v_add_u32 v49, 327680, v44
    s_lshr_b32 s34, s63, 3
    s_lshl_b32 s34, s34, 7
    s_and_b32 s35, s63, 3
    s_lshl_b32 s35, s35, 5
    s_add_u32 s34, s34, s35
    s_and_b32 s35, s63, 4
    s_add_u32 s34, s34, s35
    v_lshl_add_u32 v51, v15, 3, v14
    v_add_lshl_u32 v51, v51, s34, 1
    global_load_ushort v43, v51, s[4:5]
    s_lshl_b32 s34, s34, 2
    s_and_b32 s35, s29, 3
    s_lshl_b32 s35, s35, 15
    s_add_u32 s34, s34, s35
    s_add_u32 s34, s34, 262144
    v_bfe_u32 v50, v0, 2, 3
    v_and_b32 v52, 4, v50
    v_add_u32 v50, v50, v52
    v_lshl_add_u32 v50, v50, 11, v10
    v_lshl_add_u32 v50, v15, 5, v50
    v_add_u32 v50, s34, v50
    v_mov_b32 v52, 471040
    v_mov_b32 v53, s3
    v_lshrrev_b32 v9, 1, v50
    v_xor_b32 v9, v9, v50
    v_bfe_u32 v9, v9, 4, 1
    v_lshlrev_b32 v9, 7, v9
    v_xor_b32 v9, s3, v9
    v_and_b32 v9, 255, v9
    v_mov_b32 v116, v8
    v_mov_b32 v117, 0
    v_mov_b32 v118, 0
    v_mov_b32 v119, 0
    v_mov_b32 v36, v9
    v_mov_b32 v37, 0
    v_mov_b32 v38, 0
    v_mov_b32 v39, 0
    s_barrier
    s_barrier
    s_mov_b32 exec_hi, 0
    global_load_dword v62, v127, s[12:13]
    s_mov_b32 exec_hi, -1
    s_barrier
    buffer_load_dword v62, v61, s[64:67], 0 offen
    global_load_dwordx4 v[96:99], v44, s[26:27] sc1
    global_load_dwordx4 v[100:103], v45, s[26:27] sc1
    global_load_dwordx4 v[104:107], v46, s[26:27] sc1
    global_load_dwordx4 v[108:111], v47, s[26:27] sc1
    global_load_dwordx4 v[112:115], v48, s[26:27] sc1
    s_mov_b64 exec, 0xffffff
    global_load_dwordx4 v[116:119], v49, s[26:27] sc1
    s_mov_b64 exec, -1
    s_mov_b32 s62, 262144
L_rb:
    s_sleep 1
    s_mov_b32 exec_hi, 0
    global_load_dwordx4 v[36:39], v50, s[26:27] sc1
    s_mov_b32 exec_hi, -1
    s_sub_u32 s62, s62, 1
    s_cbranch_scc1 L_rbok
    s_waitcnt vmcnt(0)
    v_xor_b32 v40, v36, v9
    v_and_b32 v42, v11, v40
    v_cmp_ne_u32 vcc, 0, v42
    s_nop 0
    s_cbranch_vccnz L_rb
L_rbok:
    s_cmp_lg_u32 s63, 0
    s_cbranch_scc1 L_notag
    s_mov_b64 exec, 1
    global_store_dword v52, v53, s[26:27] sc1
    s_mov_b64 exec, -1
L_notag:
    v_permlane32_swap_b32 v40, v38
    v_permlane32_swap_b32 v37, v39
    s_nop 1
    v_permlane16_swap_b32 v40, v37
    v_add_f32 v40, v40, v37
    v_lshlrev_b32 v43, 16, v43
    s_nop 0
    v_add_f32_dpp v40, v40, v40 row_ror:8 row_mask:0xf bank_mask:0xf
    s_nop 1
    v_add_f32_dpp v40, v40, v40 row_ror:4 row_mask:0xf bank_mask:0xf
    v_add_f32 v40, v40, v43
    v_cvt_pk_bf16_f32 v40, v40, v40
    v_lshlrev_b32 v40, 16, v40
    s_mov_b32 s62, 262144
L_again_10:
    global_load_dwordx4 v[96:99], v44, s[26:27] sc1
    global_load_dwordx4 v[100:103], v45, s[26:27] sc1
    global_load_dwordx4 v[104:107], v46, s[26:27] sc1
    global_load_dwordx4 v[108:111], v47, s[26:27] sc1
    global_load_dwordx4 v[112:115], v48, s[26:27] sc1
    s_mov_b64 exec, 0xffffff
    global_load_dwordx4 v[116:119], v49, s[26:27] sc1
    s_mov_b64 exec, -1
    s_sub_u32 s62, s62, 1
    s_cbranch_scc1 L_ok_12
L_chk_11:
    s_waitcnt vmcnt(4)
    v_xor_b32 v120, v96, v8
    v_xor_b32 v121, v100, v8
    v_or_b32 v42, v120, v121
    v_pk_add_f32 v[18:19], v[98:99], v[102:103]
    v_add_f32 v16, v120, v121
    v_add_f32 v17, v97, v101
    s_waitcnt vmcnt(2)
    v_xor_b32 v122, v104, v8
    v_xor_b32 v123, v108, v8
    v_or3_b32 v42, v42, v122, v123
    v_pk_add_f32 v[22:23], v[106:107], v[110:111]
    v_add_f32 v20, v122, v123
    v_add_f32 v21, v105, v109
    v_pk_add_f32 v[18:19], v[18:19], v[22:23]
    v_pk_add_f32 v[16:17], v[16:17], v[20:21]
    s_waitcnt vmcnt(0)
    v_xor_b32 v124, v112, v8
    v_xor_b32 v125, v116, v8
    v_or_b32 v42, v42, v124
    v_bitop3_b32 v42, v42, v125, v11 bitop3:0xa8
    v_cmp_ne_u32 vcc, 0, v42
    v_pk_add_f32 v[26:27], v[114:115], v[118:119]
    s_cbranch_vccnz L_again_10
L_ok_12:
    v_add_f32 v24, v124, v125
    v_add_f32 v25, v113, v117
    v_pk_add_f32 v[18:19], v[18:19], v[26:27]
    v_pk_add_f32 v[16:17], v[16:17], v[24:25]
    s_nop 1
    v_permlane32_swap_b32 v16, v18
    v_permlane32_swap_b32 v17, v19
    v_pk_add_f32 v[16:17], v[16:17], v[18:19]
    s_nop 1
    v_permlane16_swap_b32 v16, v17
    v_add_f32 v16, v16, v17
    s_nop 1
    v_add_f32_dpp v16, v16, v16 row_ror:8 row_mask:0xf bank_mask:0xf
    s_nop 1
    v_add_f32_dpp v16, v16, v16 row_ror:4 row_mask:0xf bank_mask:0xf
    s_mov_b32 exec_lo, 0x000f000f
    v_add_f32 v16, v16, v40
    s_mov_b32 exec_hi, 0x000f000f
    v_cvt_pk_bf16_f32 v16, v16, v16
    global_store_short v51, v16, s[22:23]
    s_endpgm
L_norole:
    s_barrier
    s_barrier
    s_mov_b32 exec_hi, 0
    global_load_dword v62, v127, s[12:13]
    s_mov_b32 exec_hi, -1
    s_barrier
    buffer_load_dword v62, v61, s[64:67], 0 offen
    s_endpgm
.p2align 12
L_rolef:
    s_mul_i32 s63, s29, 11
    s_add_u32 s63, s63, s30
    s_sub_u32 s63, s63, 16
    s_cmp_ge_u32 s63, 86
    s_cbranch_scc1 L_norole
    s_mul_i32 s34, s28, 352256
    s_lshl_b32 s35, s63, 5
    s_add_u32 s34, s34, s35
    s_add_u32 s36, s16, s34
    s_addc_u32 s37, s17, 0
    s_mov_b32 s38, 349536
    s_mov_b32 s39, 0x20000
    s_add_u32 s40, s18, s34
    s_addc_u32 s41, s19, 0
    s_mov_b32 s42, 349536
    s_mov_b32 s43, 0x20000
    s_lshl_b32 s34, s63, 14
    s_lshl_b32 s35, s28, 8
    s_add_u32 s34, s34, s35
    s_add_u32 s20, s20, s34
    s_addc_u32 s21, s21, 0
    s_add_u32 s4, s4, s35
    s_addc_u32 s5, s5, 0
    s_and_b32 s34, s29, 3
    s_lshl_b32 s34, s34, 15
    s_lshl1_add_u32 s34, s35, s34
    s_add_u32 s34, s34, 266240
    s_add_u32 s44, s26, s34
    s_addc_u32 s45, s27, 0
    v_lshl_add_u32 v6, v12, 14, v13
    v_add_u32 v6, v6, v10
    v_and_b32 v58, 12, v0
    v_add_u32 v58, v58, v14
    v_mul_u32_u24 v58, 80, v58
    v_lshl_add_u32 v58, v15, 4, v58
    v_bfe_u32 v15, v0, 3, 1
    v_lshl_add_u32 v15, v15, 3, v12
    v_bfe_u32 v33, v0, 2, 1
    v_lshl_add_u32 v15, v15, 1, v33
    v_bfe_u32 v33, v0, 4, 1
    v_lshl_add_u32 v15, v15, 1, v33
    v_bfe_u32 v33, v0, 1, 1
    v_lshl_add_u32 v15, v15, 1, v33
    v_mul_u32_u24 v15, 2752, v15
    v_and_b32 v40, 1, v0
    v_lshlrev_b32 v40, 4, v40
    v_add_u32 v15, v15, v40
    v_lshl_add_u32 v33, v0, 3, s47
    v_lshrrev_b32 v36, 1, v13
    v_lshl_add_u32 v36, v12, 2, v36
    global_load_dword v32, v36, s[4:5]
    v_and_b32 v38, 15, v0
    v_lshlrev_b32 v34, 4, v38
    v_lshl_add_u32 v34, v14, 10, v34
    v_add_u32 v34, 0x1000, v34
    v_add_u32 v35, 0x2000, v34
    s_lshl_b32 s34, s28, 3
    v_lshl_add_u32 v60, v12, 2, s34
    s_add_u32 s34, s34, 1024
    v_mul_u32_u24 v57, 80, v38
    v_add_u32 v57, s34, v57
    v_lshl_add_u32 v57, v14, 2, v57
    s_andn2_b32 s34, s63, 3
    s_add_u32 s34, s34, s63
    s_lshl2_add_u32 s34, s34, s28
    s_lshl_b32 s34, s34, 9
    s_add_u32 s34, s34, 524288
    v_lshl_add_u32 v59, v12, 13, v13
    v_add_u32 v59, s34, v59
    v_mov_b32 v44, 0x3f803f80
    v_mov_b32 v63, 6144
    v_mov_b32 v46, 0xbb000000
    v_mov_b32 v47, 0x3b000000
    v_mov_b32 v41, 0xffff
    v_lshlrev_b32 v40, v40, v41
    v_bfe_u32 v41, v0, 1, 2
    s_mov_b32 s60, 1
    s_mov_b32 s61, 1
    v_mov_b32 v72, v44
    v_mov_b32 v73, v44
    v_mov_b32 v74, v44
    v_mov_b32 v75, v44
    v_mov_b32 v76, v44
    v_mov_b32 v77, v44
    v_mov_b32 v78, v44
    v_mov_b32 v79, v44
    v_mov_b32 v80, v44
    v_mov_b32 v81, v44
    v_mov_b32 v82, v44
    v_mov_b32 v83, v44
    v_mov_b32 v84, v44
    v_mov_b32 v85, v44
    v_mov_b32 v86, v44
    v_mov_b32 v87, v44
    v_cmp_eq_u32 vcc, 0, v41
    s_nop 1
    v_cndmask_b32 v48, 0, v40, vcc
    v_cmp_eq_u32 vcc, 1, v41
    s_nop 1
    v_cndmask_b32 v49, 0, v40, vcc
    v_cmp_eq_u32 vcc, 2, v41
    s_nop 1
    v_cndmask_b32 v50, 0, v40, vcc
    v_cmp_eq_u32 vcc, 3, v41
    s_nop 1
    v_cndmask_b32 v51, 0, v40, vcc
    s_barrier
    s_barrier
    s_mov_b32 exec_hi, 0
    global_load_dword v62, v127, s[12:13]
    s_mov_b32 exec_hi, -1
    s_barrier
    buffer_load_dword v62, v61, s[64:67], 0 offen
    s_add_u32 m0, s47, 0
    s_mov_b32 s34, 0
    buffer_load_dwordx4 v15, s[36:39], s34 offen lds
    s_add_u32 m0, s47, 4096
    s_mov_b32 s34, 0
    buffer_load_dwordx4 v15, s[40:43], s34 offen lds
    s_add_u32 m0, s47, 1024
    s_mov_b32 s34, 44032
    buffer_load_dwordx4 v15, s[36:39], s34 offen lds
    s_add_u32 m0, s47, 5120
    s_mov_b32 s34, 44032
    buffer_load_dwordx4 v15, s[40:43], s34 offen lds
    s_add_u32 m0, s47, 2048
    s_mov_b32 s34, 88064
    buffer_load_dwordx4 v15, s[36:39], s34 offen lds
    s_add_u32 m0, s47, 6144
    s_mov_b32 s34, 88064
    buffer_load_dwordx4 v15, s[40:43], s34 offen lds
    s_add_u32 m0, s47, 3072
    s_mov_b32 s34, 132096
    buffer_load_dwordx4 v15, s[36:39], s34 offen lds
    s_add_u32 m0, s47, 7168
    s_mov_b32 s34, 132096
    buffer_load_dwordx4 v15, s[40:43], s34 offen lds
    s_waitcnt vmcnt(6)
    ds_read_b64_tr_b16 v[128:129], v33 offset:0
    ds_read_b64_tr_b16 v[130:131], v33 offset:512
    ds_read_b64_tr_b16 v[144:145], v33 offset:4096
    ds_read_b64_tr_b16 v[146:147], v33 offset:4608
    v_and_b32 v41, 0xffff0000, v32
    v_lshlrev_b32 v40, 16, v32
    s_waitcnt vmcnt(4)
    ds_read_b64_tr_b16 v[132:133], v33 offset:1024
    ds_read_b64_tr_b16 v[134:135], v33 offset:1536
    ds_read_b64_tr_b16 v[148:149], v33 offset:5120
    ds_read_b64_tr_b16 v[150:151], v33 offset:5632
    s_waitcnt vmcnt(2)
    global_load_dwordx4 v[96:99], v6, s[44:45] offset:-4096 sc1
    global_load_dwordx4 v[100:103], v6, s[44:45] offset:-2048 sc1
    global_load_dwordx4 v[104:107], v6, s[44:45] offset:0 sc1
    global_load_dwordx4 v[108:111], v6, s[44:45] offset:2048 sc1
    ds_read_b64_tr_b16 v[136:137], v33 offset:2048
    ds_read_b64_tr_b16 v[138:139], v33 offset:2560
    ds_read_b64_tr_b16 v[152:153], v33 offset:6144
    ds_read_b64_tr_b16 v[154:155], v33 offset:6656
    s_waitcnt vmcnt(4)
    ds_read_b64_tr_b16 v[140:141], v33 offset:3072
    ds_read_b64_tr_b16 v[142:143], v33 offset:3584
    ds_read_b64_tr_b16 v[156:157], v33 offset:7168
    ds_read_b64_tr_b16 v[158:159], v33 offset:7680
    s_mov_b32 s62, 262144
    s_branch L_chk_14
L_again_13:
    global_load_dwordx4 v[96:99], v6, s[44:45] offset:-4096 sc1
    global_load_dwordx4 v[100:103], v6, s[44:45] offset:-2048 sc1
    global_load_dwordx4 v[104:107], v6, s[44:45] offset:0 sc1
    global_load_dwordx4 v[108:111], v6, s[44:45] offset:2048 sc1
    s_sub_u32 s62, s62, 1
    s_cbranch_scc1 L_ok_15
L_chk_14:
    s_waitcnt vmcnt(2)
    v_xor_b32 v120, v96, v8
    v_xor_b32 v121, v100, v8
    v_or_b32 v42, v120, v121
    v_pk_add_f32 v[18:19], v[98:99], v[102:103]
    v_add_f32 v16, v120, v121
    v_add_f32 v17, v97, v101
    s_waitcnt vmcnt(0)
    v_xor_b32 v122, v104, v8
    v_xor_b32 v123, v108, v8
    v_or_b32 v42, v42, v122
    v_bitop3_b32 v42, v42, v123, v11 bitop3:0xa8
    v_cmp_ne_u32 vcc, 0, v42
    v_pk_add_f32 v[22:23], v[106:107], v[110:111]
    s_cbranch_vccnz L_again_13
L_ok_15:
    v_add_f32 v20, v122, v123
    v_add_f32 v21, v105, v109
    v_pk_add_f32 v[18:19], v[18:19], v[22:23]
    v_pk_add_f32 v[16:17], v[16:17], v[20:21]
    s_nop 1
    v_permlane32_swap_b32 v16, v18
    v_permlane32_swap_b32 v17, v19
    v_pk_add_f32 v[16:17], v[16:17], v[18:19]
    v_pk_add_f32 v[16:17], v[16:17], v[40:41]
    v_cvt_pk_bf16_f32 v18, v16, v17
    v_dot2_f32_bf16 v16, v18, v44, 0
    v_dot2_f32_bf16 v17, v18, v18, 0
    s_waitcnt lgkmcnt(0)
    global_load_dwordx4 v[160:163], v34, s[20:21] offset:-4096
    global_load_dwordx4 v[164:167], v34, s[20:21] offset:0
    global_load_dwordx4 v[168:171], v35, s[20:21] offset:-4096
    global_load_dwordx4 v[172:175], v35, s[20:21] offset:0
    v_mov_b32_dpp v72, v18 row_newbcast:0 row_mask:0xf bank_mask:0xd
    v_mov_b32_dpp v73, v18 row_newbcast:1 row_mask:0xf bank_mask:0xd
    v_permlane32_swap_b32 v16, v17
    v_mov_b32_dpp v74, v18 row_newbcast:2 row_mask:0xf bank_mask:0xd
    v_add_f32 v16, v16, v17
    v_mov_b32_dpp v75, v18 row_newbcast:3 row_mask:0xf bank_mask:0xd
    v_mov_b32_dpp v76, v18 row_newbcast:4 row_mask:0xf bank_mask:0xd
    v_add_f32_dpp v16, v16, v16 row_ror:8 row_mask:0xf bank_mask:0xf
    v_mfma_f32_16x16x32_bf16 v[64:67], v[72:75], v[128:131], 0
    v_mov_b32_dpp v77, v18 row_newbcast:5 row_mask:0xf bank_mask:0xd
    v_add_f32_dpp v16, v16, v16 row_ror:4 row_mask:0xf bank_mask:0xf
    v_mov_b32_dpp v78, v18 row_newbcast:6 row_mask:0xf bank_mask:0xd
    v_mfma_f32_16x16x32_bf16 v[68:71], v[72:75], v[144:147], 0
    v_add_f32_dpp v16, v16, v16 row_ror:2 row_mask:0xf bank_mask:0xf
    v_mov_b32_dpp v79, v18 row_newbcast:7 row_mask:0xf bank_mask:0xd
    v_mov_b32_dpp v80, v18 row_newbcast:8 row_mask:0xf bank_mask:0xd
    v_add_f32_dpp v16, v16, v16 row_ror:1 row_mask:0xf bank_mask:0xf
    v_mov_b32 v17, v16
    v_mfma_f32_16x16x32_bf16 v[64:67], v[76:79], v[132:135], v[64:67]
    v_mov_b32_dpp v81, v18 row_newbcast:9 row_mask:0xf bank_mask:0xd
    v_permlane16_swap_b32 v16, v17
    v_add_f32 v16, v16, v17
    s_mov_b64 exec, s[60:61]
    ds_write_b32 v60, v16 offset:6144
    s_mov_b64 exec, -1
    v_mfma_f32_16x16x32_bf16 v[68:71], v[76:79], v[148:151], v[68:71]
    v_mov_b32_dpp v82, v18 row_newbcast:10 row_mask:0xf bank_mask:0xd
    v_mov_b32_dpp v83, v18 row_newbcast:11 row_mask:0xf bank_mask:0xd
    v_mov_b32_dpp v84, v18 row_newbcast:12 row_mask:0xf bank_mask:0xd
    v_mov_b32_dpp v85, v18 row_newbcast:13 row_mask:0xf bank_mask:0xd
    v_mfma_f32_16x16x32_bf16 v[64:67], v[80:83], v[136:139], v[64:67]
    v_mov_b32_dpp v86, v18 row_newbcast:14 row_mask:0xf bank_mask:0xd
    v_mov_b32_dpp v87, v18 row_newbcast:15 row_mask:0xf bank_mask:0xd
    v_mfma_f32_16x16x32_bf16 v[68:71], v[80:83], v[152:155], v[68:71]
    s_nop 0
    v_mfma_f32_16x16x32_bf16 v[64:67], v[84:87], v[140:143], v[64:67]
    s_waitcnt lgkmcnt(0)
    s_barrier
    v_mfma_f32_16x16x32_bf16 v[68:71], v[84:87], v[156:159], v[68:71]
    ds_read_b128 v[24:27], v63
    ds_read_b128 v[28:31], v63 offset:16
    s_mov_b32 exec_hi, 0
    s_nop 4
    ds_write2_b32 v57, v64, v68 offset0:0 offset1:8
    s_mov_b32 exec_hi, -1
    s_waitcnt lgkmcnt(1)
    v_pk_add_f32 v[24:25], v[24:25], v[26:27]
    v_pk_add_f32 v[28:29], v[28:29], v[30:31]
    v_pk_add_f32 v[24:25], v[24:25], v[28:29]
    s_waitcnt lgkmcnt(0)
    s_barrier
    ds_read_b128 v[16:19], v58 offset:1024
    v_pk_mul_f32 v[24:25], v[24:25], v[46:47]
    v_fma_f32 v28, -v24, v24, v25
    v_max_f32 v28, 0, v28
    v_add_f32 v28, 0x3727c5ac, v28
    v_rsq_f32 v29, v28
    s_waitcnt lgkmcnt(0)
    v_pk_add_f32 v[16:17], v[16:17], v[18:19]
    v_fmac_f32 v16, v24, v17
    v_rcp_f32 v28, v28
    v_mul_f32 v29, 0xbfb8aa3b, v29
    v_add_f32_dpp v16, v16, v16 quad_perm:[1,0,3,2] row_mask:0xf bank_mask:0xf
    v_mul_f32 v17, v16, v29
    v_exp_f32 v17, v17
    v_mul_f32_dpp v18, v16, v16 quad_perm:[2,3,0,1] row_mask:0xf bank_mask:0xf
    v_add_f32 v17, 1.0, v17
    v_rcp_f32 v17, v17
    v_mul_f32 v18, v18, v28
    v_mul_f32 v16, v18, v17
    v_cvt_pk_bf16_f32 v16, v16, v16
    s_waitcnt vmcnt(0)
    s_nop 0
    v_and_b32_dpp v72, v16, v48 row_newbcast:0 row_mask:0xf bank_mask:0xf
    v_and_b32_dpp v73, v16, v49 row_newbcast:0 row_mask:0xf bank_mask:0xf
    v_and_b32_dpp v74, v16, v50 row_newbcast:0 row_mask:0xf bank_mask:0xf
    v_and_b32_dpp v75, v16, v51 row_newbcast:0 row_mask:0xf bank_mask:0xf
    v_and_b32_dpp v76, v16, v48 row_newbcast:4 row_mask:0xf bank_mask:0xf
    v_and_b32_dpp v77, v16, v49 row_newbcast:4 row_mask:0xf bank_mask:0xf
    v_mfma_f32_16x16x32_bf16 v[64:67], v[72:75], v[160:163], 0
    v_and_b32_dpp v78, v16, v50 row_newbcast:4 row_mask:0xf bank_mask:0xf
    v_and_b32_dpp v79, v16, v51 row_newbcast:4 row_mask:0xf bank_mask:0xf
    v_and_b32_dpp v80, v16, v48 row_newbcast:8 row_mask:0xf bank_mask:0xf
    v_and_b32_dpp v81, v16, v49 row_newbcast:8 row_mask:0xf bank_mask:0xf
    v_mfma_f32_16x16x32_bf16 v[64:67], v[76:79], v[164:167], v[64:67]
    v_and_b32_dpp v82, v16, v50 row_newbcast:8 row_mask:0xf bank_mask:0xf
    v_and_b32_dpp v83, v16, v51 row_newbcast:8 row_mask:0xf bank_mask:0xf
    v_and_b32_dpp v84, v16, v48 row_newbcast:12 row_mask:0xf bank_mask:0xf
    v_and_b32_dpp v85, v16, v49 row_newbcast:12 row_mask:0xf bank_mask:0xf
    v_mfma_f32_16x16x32_bf16 v[64:67], v[80:83], v[168:171], v[64:67]
    v_and_b32_dpp v86, v16, v50 row_newbcast:12 row_mask:0xf bank_mask:0xf
    v_and_b32_dpp v87, v16, v51 row_newbcast:12 row_mask:0xf bank_mask:0xf
    s_nop 1
    v_mfma_f32_16x16x32_bf16 v[64:67], v[84:87], v[172:175], v[64:67]
    s_nop 7
    v_bfi_b32 v64, v11, v8, v64
    global_store_dwordx4 v59, v[64:67], s[26:27] sc1
    s_endpgm
.p2align 12
L_vwave:
    s_add_u32 s36, s8, s34
    s_addc_u32 s37, s9, 0
    s_lshl3_add_u32 s35, s31, s32
    s_lshl_b32 s35, s35, 10
    s_add_u32 s44, s26, s35
    s_addc_u32 s45, s27, 0
    v_mov_b32 v56, 6656
    s_lshr_b32 s56, s2, 6
    s_lshl_b32 s56, s56, 7
    s_and_b32 s35, s2, 63
    s_add_u32 s56, s56, s35
    s_lshl_b32 s56, s56, 7
    s_add_u32 s56, s56, 393216
    s_cmp_lg_u32 s28, 5
    s_cbranch_scc1 L_nowarm
    s_load_dword s54, s[26:27], s56 glc
    s_load_dword s55, s[26:27], s56 offset:0x2000 glc
L_nowarm:
    v_and_b32 v28, 1, v0
    v_cmp_eq_u32 vcc, 1, v28
    v_mov_b32 v29, 0x0c0c0100
    v_mov_b32 v30, 0x01000c0c
    v_cndmask_b32 v29, v29, v30, vcc
    v_mov_b32 v30, 0x0c0c0302
    v_mov_b32 v31, 0x03020c0c
    v_cndmask_b32 v30, v30, v31, vcc
    v_mov_b32 v31, 0x0c0c0c0c
    v_bfe_u32 v28, v0, 1, 2
    v_cmp_eq_u32 vcc, 0, v28
    s_nop 1
    v_cndmask_b32 v40, v31, v29, vcc
    v_cndmask_b32 v44, v31, v30, vcc
    v_cmp_eq_u32 vcc, 1, v28
    s_nop 1
    v_cndmask_b32 v41, v31, v29, vcc
    v_cndmask_b32 v45, v31, v30, vcc
    v_cmp_eq_u32 vcc, 2, v28
    s_nop 1
    v_cndmask_b32 v42, v31, v29, vcc
    v_cndmask_b32 v46, v31, v30, vcc
    v_cmp_eq_u32 vcc, 3, v28
    s_nop 1
    v_cndmask_b32 v43, v31, v29, vcc
    v_cndmask_b32 v47, v31, v30, vcc
    s_lshl_b32 s34, s63, 10
    s_add_u32 s34, s34, 1024
    v_lshrrev_b32 v12, 5, v0
    v_lshl_add_u32 v12, v12, 9, s34
    v_lshl_add_u32 v12, v4, 1, v12
    v_bfe_u32 v13, v0, 4, 1
    v_lshl_add_u32 v12, v13, 4, v12
    v_lshlrev_b32 v14, 3, v0
    s_lshl_b32 s34, s32, 5
    s_add_u32 s34, s34, s63
    s_lshl_b32 s34, s34, 2
    v_lshl_add_u32 v6, v3, 4, s34
    v_mov_b32 v57, 1
    s_waitcnt vmcnt(4)
    v_lshlrev_b32 v28, 16, v24
    v_and_b32 v29, 0xffff0000, v24
    v_lshlrev_b32 v30, 16, v25
    v_and_b32 v31, 0xffff0000, v25
    v_lshlrev_b32 v32, 16, v26
    v_and_b32 v33, 0xffff0000, v26
    v_lshlrev_b32 v34, 16, v27
    v_and_b32 v35, 0xffff0000, v27
    v_add_f32 v36, v28, v29
    v_add_f32 v37, v30, v31
    v_add_f32 v38, v32, v33
    v_add_f32 v39, v34, v35
    v_add_f32 v36, v36, v37
    v_add_f32 v38, v38, v39
    v_add_f32 v36, v36, v38
    s_nop 1
    v_add_f32_dpp v36, v36, v36 row_ror:8 row_mask:0xf bank_mask:0xf
    s_nop 1
    v_add_f32_dpp v36, v36, v36 row_ror:4 row_mask:0xf bank_mask:0xf
    s_nop 1
    v_add_f32_dpp v36, v36, v36 row_ror:2 row_mask:0xf bank_mask:0xf
    s_nop 1
    v_add_f32_dpp v36, v36, v36 row_ror:1 row_mask:0xf bank_mask:0xf
    v_mov_b32 v37, v36
    s_nop 1
    v_permlane16_swap_b32 v36, v37
    v_add_f32 v36, v36, v37
    v_mov_b32 v37, v36
    s_nop 1
    v_permlane32_swap_b32 v36, v37
    v_add_f32 v36, v36, v37
    v_mul_f32 v39, 0x3b000000, v36
    v_cvt_pk_bf16_f32 v38, v39, v39
    v_lshlrev_b32 v38, 16, v38
    v_sub_f32 v28, v28, v38
    v_sub_f32 v29, v29, v38
    v_sub_f32 v30, v30, v38
    v_sub_f32 v31, v31, v38
    v_sub_f32 v32, v32, v38
    v_sub_f32 v33, v33, v38
    v_sub_f32 v34, v34, v38
    v_sub_f32 v35, v35, v38
    v_sub_f32 v39, v39, v38
    v_mul_f32 v36, v28, v28
    v_mul_f32 v37, v29, v29
    v_fmac_f32 v36, v30, v30
    v_fmac_f32 v37, v31, v31
    v_fmac_f32 v36, v32, v32
    v_fmac_f32 v37, v33, v33
    v_fmac_f32 v36, v34, v34
    v_fmac_f32 v37, v35, v35
    v_add_f32 v36, v36, v37
    v_cvt_pk_bf16_f32 v24, v28, v29
    v_cvt_pk_bf16_f32 v25, v30, v31
    v_add_f32_dpp v36, v36, v36 row_ror:8 row_mask:0xf bank_mask:0xf
    v_cvt_pk_bf16_f32 v26, v32, v33
    v_cvt_pk_bf16_f32 v27, v34, v35
    v_add_f32_dpp v36, v36, v36 row_ror:4 row_mask:0xf bank_mask:0xf
    v_lshlrev_b32 v28, 16, v24
    v_and_b32 v29, 0xffff0000, v24
    v_add_f32_dpp v36, v36, v36 row_ror:2 row_mask:0xf bank_mask:0xf
    v_lshlrev_b32 v30, 16, v25
    v_and_b32 v31, 0xffff0000, v25
    v_add_f32_dpp v36, v36, v36 row_ror:1 row_mask:0xf bank_mask:0xf
    v_mov_b32 v37, v36
    v_lshlrev_b32 v32, 16, v26
    v_and_b32 v33, 0xffff0000, v26
    v_permlane16_swap_b32 v36, v37
    v_add_f32 v36, v36, v37
    v_mov_b32 v37, v36
    v_lshlrev_b32 v34, 16, v27
    v_and_b32 v35, 0xffff0000, v27
    v_permlane32_swap_b32 v36, v37
    v_add_f32 v36, v36, v37
    v_mul_f32 v39, v39, v39
    v_mul_f32 v36, 0x3b000000, v36
    v_sub_f32 v36, v36, v39
    v_max_f32 v36, 0, v36
    v_cvt_pk_bf16_f32 v36, v36, v36
    v_lshlrev_b32 v36, 16, v36
    v_add_f32 v36, 0x3727c5ac, v36
    v_cvt_pk_bf16_f32 v36, v36, v36
    v_lshlrev_b32 v36, 16, v36
    v_sqrt_f32 v36, v36
    s_nop 0
    v_cvt_pk_bf16_f32 v36, v36, v36
    v_lshlrev_b32 v36, 16, v36
    v_rcp_f32 v36, v36
    s_nop 0
    v_mul_f32 v28, v28, v36
    v_mul_f32 v29, v29, v36
    v_mul_f32 v30, v30, v36
    v_mul_f32 v31, v31, v36
    v_mul_f32 v32, v32, v36
    v_mul_f32 v33, v33, v36
    v_mul_f32 v34, v34, v36
    v_mul_f32 v35, v35, v36
    v_cvt_pk_bf16_f32 v24, v28, v29
    v_cvt_pk_bf16_f32 v25, v30, v31
    v_cvt_pk_bf16_f32 v26, v32, v33
    v_cvt_pk_bf16_f32 v27, v34, v35
    ds_write_b128 v5, v[24:27] offset:5120
    s_waitcnt lgkmcnt(0)
    ds_read_b32 v48, v6 offset:5120
    s_add_u32 s3, s3, 0x5bd1e3c7
    v_lshrrev_b32 v8, 1, v14
    v_xor_b32 v8, v8, v14
    v_bfe_u32 v8, v8, 4, 1
    v_lshlrev_b32 v8, 3, v8
    v_xor_b32 v8, s3, v8
    v_xor_b32 v8, 4, v8
    v_and_b32 v8, 15, v8
    s_waitcnt lgkmcnt(0)
    v_perm_b32 v24, v48, v48, v40
    v_perm_b32 v25, v48, v48, v41
    v_perm_b32 v26, v48, v48, v42
    v_perm_b32 v27, v48, v48, v43
    v_perm_b32 v28, v48, v48, v44
    v_perm_b32 v29, v48, v48, v45
    v_perm_b32 v30, v48, v48, v46
    v_perm_b32 v31, v48, v48, v47
    s_waitcnt vmcnt(0)
    v_mfma_f32_16x16x32_bf16 v[16:19], v[24:27], v[64:67], 0
    v_mfma_f32_16x16x32_bf16 v[20:23], v[24:27], v[68:71], 0
    v_mfma_f32_16x16x32_bf16 v[16:19], v[28:31], v[72:75], v[16:19]
    v_mfma_f32_16x16x32_bf16 v[20:23], v[28:31], v[76:79], v[20:23]
    s_mov_b32 exec_lo, 0x00ff00ff
    s_mov_b32 exec_hi, 0xff00ff00
    s_nop 4
    ds_write_b128 v12, v[16:19]
    ds_write_b128 v12, v[20:23] offset:256
    s_mov_b64 exec, 1
    s_waitcnt lgkmcnt(0)
    ds_add_u32 v56, v57 offset:48
    s_mov_b64 exec, -1
    s_cmp_lg_u32 s28, 4
    s_cbranch_scc1 L_vstream
    s_mov_b32 s62, 262144
L_spin_16:
    ds_read_b32 v15, v56 offset:48
    s_waitcnt lgkmcnt(0)
    v_cmp_ne_u32 vcc, 4, v15
    s_nop 0
    s_cbranch_vccz L_spun_17
    s_sub_u32 s62, s62, 1
    s_cbranch_scc0 L_spin_16
L_spun_17:
    ds_read_b128 v[16:19], v5 offset:1024
    ds_read_b128 v[20:23], v5 offset:2048
    ds_read_b128 v[24:27], v5 offset:3072
    ds_read_b128 v[28:31], v5 offset:4096
    s_waitcnt lgkmcnt(0)
    v_pk_add_f32 v[16:17], v[16:17], v[20:21]
    v_pk_add_f32 v[18:19], v[18:19], v[22:23]
    v_pk_add_f32 v[24:25], v[24:25], v[28:29]
    v_pk_add_f32 v[26:27], v[26:27], v[30:31]
    v_pk_add_f32 v[16:17], v[16:17], v[24:25]
    v_pk_add_f32 v[18:19], v[18:19], v[26:27]
    s_nop 1
    v_permlane32_swap_b32 v16, v18
    v_permlane32_swap_b32 v17, v19
    v_pk_add_f32 v[16:17], v[16:17], v[18:19]
    v_and_or_b32 v16, v16, -16, v8
    v_and_or_b32 v17, v17, -16, v8
    global_store_dwordx2 v14, v[16:17], s[44:45]
L_vstream:
    s_setprio 0
    s_getreg_b32 s34, hwreg(HW_REG_XCC_ID, 0, 4)
    s_andn2_b32 s46, s3, 31
    s_or_b32 s46, s46, s34
    s_lshl_b32 s47, s29, 8
    s_add_u32 s47, s47, 466944
    s_cmp_lg_u32 s28, 5
    s_cbranch_scc1 L_noprobe
    s_mov_b32 s54, -1
    s_mov_b32 s55, -1
    s_waitcnt lgkmcnt(0)
    s_memtime s[50:51]
    s_load_dword s35, s[26:27], s56 offset:0 glc
    s_waitcnt lgkmcnt(0)
    s_memtime s[52:53]
    s_waitcnt lgkmcnt(0)
    s_sub_u32 s35, s52, s50
    s_min_u32 s54, s54, s35
    s_memtime s[50:51]
    s_load_dword s35, s[26:27], s56 offset:8192 glc
    s_waitcnt lgkmcnt(0)
    s_memtime s[52:53]
    s_waitcnt lgkmcnt(0)
    s_sub_u32 s35, s52, s50
    s_min_u32 s55, s55, s35
    s_memtime s[50:51]
    s_load_dword s35, s[26:27], s56 offset:0 glc
    s_waitcnt lgkmcnt(0)
    s_memtime s[52:53]
    s_waitcnt lgkmcnt(0)
    s_sub_u32 s35, s52, s50
    s_min_u32 s54, s54, s35
    s_memtime s[50:51]
    s_load_dword s35, s[26:27], s56 offset:8192 glc
    s_waitcnt lgkmcnt(0)
    s_memtime s[52:53]
    s_waitcnt lgkmcnt(0)
    s_sub_u32 s35, s52, s50
    s_min_u32 s55, s55, s35
    s_cmp_lt_u32 s55, s54
    s_cselect_b32 s35, 16, 0
    s_or_b32 s34, s46, s35
    v_mov_b32 v31, s34
    s_lshl2_add_u32 s34, s30, s47
    v_mov_b32 v30, s34
    s_mov_b64 exec, 1
    global_store_dword v30, v31, s[26:27]
    s_mov_b64 exec, -1
L_noprobe:
    s_lshl_b32 s34, s63, 2
    v_mov_b32 v28, s34
    v_and_b32 v30, 31, v0
    v_lshl_add_u32 v30, v30, 2, s47
    s_mov_b32 s62, 262144
L_spin_18:
    s_sleep 1
    ds_read_b32 v15, v28 offset:6720
    s_waitcnt lgkmcnt(0)
    v_cmp_eq_u32 vcc, 0, v15
    s_nop 0
    s_cbranch_vccz L_spun_19
    s_sub_u32 s62, s62, 1
    s_cbranch_scc0 L_spin_18
L_spun_19:
    buffer_load_dwordx4 v[128:131], v2, s[36:39], s33 offen offset:0 nt
    buffer_load_dwordx4 v[132:135], v2, s[36:39], s33 offen offset:128 nt
    s_addk_i32 s33, 0x100
    s_bitset0_b32 s33, 12
    buffer_load_dwordx4 v[136:139], v2, s[36:39], s33 offen offset:0 nt
    buffer_load_dwordx4 v[140:143], v2, s[36:39], s33 offen offset:128 nt
    s_addk_i32 s33, 0x100
    s_bitset0_b32 s33, 12
    buffer_load_dwordx4 v[144:147], v2, s[36:39], s33 offen offset:0 nt
    buffer_load_dwordx4 v[148:151], v2, s[36:39], s33 offen offset:128 nt
    s_addk_i32 s33, 0x100
    s_bitset0_b32 s33, 12
    buffer_load_dwordx4 v[152:155], v2, s[36:39], s33 offen offset:0 nt
    buffer_load_dwordx4 v[156:159], v2, s[36:39], s33 offen offset:128 nt
    s_addk_i32 s33, 0x100
    s_bitset0_b32 s33, 12
    s_waitcnt vmcnt(6)
    buffer_load_dwordx4 v[160:163], v2, s[36:39], s33 offen offset:0 nt
    buffer_load_dwordx4 v[164:167], v2, s[36:39], s33 offen offset:128 nt
    s_addk_i32 s33, 0x100
    s_bitset0_b32 s33, 12
    s_waitcnt vmcnt(6)
    buffer_load_dwordx4 v[168:171], v2, s[36:39], s33 offen offset:0 nt
    buffer_load_dwordx4 v[172:175], v2, s[36:39], s33 offen offset:128 nt
    s_addk_i32 s33, 0x100
    s_bitset0_b32 s33, 12
    s_waitcnt vmcnt(6)
    buffer_load_dwordx4 v[176:179], v2, s[36:39], s33 offen offset:0 nt
    buffer_load_dwordx4 v[180:183], v2, s[36:39], s33 offen offset:128 nt
    s_addk_i32 s33, 0x100
    s_bitset0_b32 s33, 12
    s_waitcnt vmcnt(6)
    buffer_load_dwordx4 v[184:187], v2, s[36:39], s33 offen offset:0 nt
    buffer_load_dwordx4 v[188:191], v2, s[36:39], s33 offen offset:128 nt
    global_load_dword v29, v30, s[26:27] sc1
    s_addk_i32 s33, 0x100
    s_bitset0_b32 s33, 12
    s_waitcnt vmcnt(7)
    buffer_load_dwordx4 v[192:195], v2, s[36:39], s33 offen offset:0 nt
    buffer_load_dwordx4 v[196:199], v2, s[36:39], s33 offen offset:128 nt
    s_addk_i32 s33, 0x100
    s_bitset0_b32 s33, 12
    s_waitcnt vmcnt(7)
    buffer_load_dwordx4 v[200:203], v2, s[36:39], s33 offen offset:0 nt
    buffer_load_dwordx4 v[204:207], v2, s[36:39], s33 offen offset:128 nt
    s_addk_i32 s33, 0x100
    s_bitset0_b32 s33, 12
    s_waitcnt vmcnt(7)
    buffer_load_dwordx4 v[208:211], v2, s[36:39], s33 offen offset:0 nt
    buffer_load_dwordx4 v[212:215], v2, s[36:39], s33 offen offset:128 nt
    s_addk_i32 s33, 0x100
    s_bitset0_b32 s33, 12
    s_waitcnt vmcnt(6)
    buffer_load_dwordx4 v[216:219], v2, s[36:39], s33 offen offset:0 nt
    buffer_load_dwordx4 v[220:223], v2, s[36:39], s33 offen offset:128 nt
    v_and_b32 v29, -17, v29
    v_cmp_ne_u32 s[48:49], s46, v29
    s_nop 0
    s_cmp_eq_u64 s[48:49], 0
    s_cselect_b32 s50, 1, 0
    s_cbranch_scc0 L_requeue
L_requeued:
    s_addk_i32 s33, 0x100
    s_bitset0_b32 s33, 12
    s_waitcnt vmcnt(6)
    buffer_load_dwordx4 v[224:227], v2, s[36:39], s33 offen offset:0 nt
    buffer_load_dwordx4 v[228:231], v2, s[36:39], s33 offen offset:128 nt
    s_addk_i32 s33, 0x100
    s_bitset0_b32 s33, 12
    s_waitcnt vmcnt(6)
    buffer_load_dwordx4 v[232:235], v2, s[36:39], s33 offen offset:0 nt
    buffer_load_dwordx4 v[236:239], v2, s[36:39], s33 offen offset:128 nt
    s_addk_i32 s33, 0x100
    s_bitset0_b32 s33, 12
    s_waitcnt vmcnt(6)
    buffer_load_dwordx4 v[240:243], v2, s[36:39], s33 offen offset:0 nt
    buffer_load_dwordx4 v[244:247], v2, s[36:39], s33 offen offset:128 nt
    s_addk_i32 s33, 0x100
    s_bitset0_b32 s33, 12
    s_waitcnt vmcnt(6)
    buffer_load_dwordx4 v[248:251], v2, s[36:39], s33 offen offset:0 nt
    buffer_load_dwordx4 v[252:255], v2, s[36:39], s33 offen offset:128 nt
    v_mov_b32 v11, 0xff
    v_lshrrev_b32 v8, 1, v14
    v_xor_b32 v8, v8, v14
    v_bfe_u32 v8, v8, 4, 1
    v_lshlrev_b32 v8, 7, v8
    v_xor_b32 v8, s3, v8
    v_and_b32 v8, 255, v8
    v_and_b32 v10, 15, v14
    v_cmp_eq_u32 vcc, 0, v10
    s_nop 1
    v_cndmask_b32 v10, 0, v11, vcc
    s_lshl_b32 s34, s63, 8
    v_lshl_add_u32 v6, v3, 5, s34
    s_barrier
    ds_read_b128 v[48:51], v6 offset:0
    ds_read_b128 v[52:55], v6 offset:16
    s_waitcnt lgkmcnt(0)
    v_perm_b32 v64, v48, v48, v40
    v_perm_b32 v65, v48, v48, v41
    v_perm_b32 v66, v48, v48, v42
    v_perm_b32 v67, v48, v48, v43
    v_perm_b32 v68, v48, v48, v44
    v_perm_b32 v69, v48, v48, v45
    v_perm_b32 v70, v48, v48, v46
    v_perm_b32 v71, v48, v48, v47
    v_perm_b32 v72, v49, v49, v40
    v_perm_b32 v73, v49, v49, v41
    v_perm_b32 v74, v49, v49, v42
    v_perm_b32 v75, v49, v49, v43
    v_perm_b32 v76, v49, v49, v44
    v_perm_b32 v77, v49, v49, v45
    v_perm_b32 v78, v49, v49, v46
    v_perm_b32 v79, v49, v49, v47
    v_perm_b32 v80, v50, v50, v40
    v_perm_b32 v81, v50, v50, v41
    v_perm_b32 v82, v50, v50, v42
    v_perm_b32 v83, v50, v50, v43
    v_perm_b32 v84, v50, v50, v44
    v_perm_b32 v85, v50, v50, v45
    v_perm_b32 v86, v50, v50, v46
    v_perm_b32 v87, v50, v50, v47
    v_perm_b32 v88, v51, v51, v40
    v_perm_b32 v89, v51, v51, v41
    v_perm_b32 v90, v51, v51, v42
    v_perm_b32 v91, v51, v51, v43
    v_perm_b32 v92, v51, v51, v44
    v_perm_b32 v93, v51, v51, v45
    v_perm_b32 v94, v51, v51, v46
    v_perm_b32 v95, v51, v51, v47
    v_perm_b32 v96, v52, v52, v40
    v_perm_b32 v97, v52, v52, v41
    v_perm_b32 v98, v52, v52, v42
    v_perm_b32 v99, v52, v52, v43
    v_perm_b32 v100, v52, v52, v44
    v_perm_b32 v101, v52, v52, v45
    v_perm_b32 v102, v52, v52, v46
    v_perm_b32 v103, v52, v52, v47
    v_perm_b32 v104, v53, v53, v40
    v_perm_b32 v105, v53, v53, v41
    v_perm_b32 v106, v53, v53, v42
    v_perm_b32 v107, v53, v53, v43
    v_perm_b32 v108, v53, v53, v44
    v_perm_b32 v109, v53, v53, v45
    v_perm_b32 v110, v53, v53, v46
    v_perm_b32 v111, v53, v53, v47
    v_perm_b32 v112, v54, v54, v40
    v_perm_b32 v113, v54, v54, v41
    v_perm_b32 v114, v54, v54, v42
    v_perm_b32 v115, v54, v54, v43
    v_perm_b32 v116, v54, v54, v44
    v_perm_b32 v117, v54, v54, v45
    v_perm_b32 v118, v54, v54, v46
    v_perm_b32 v119, v54, v54, v47
    v_perm_b32 v120, v55, v55, v40
    v_perm_b32 v121, v55, v55, v41
    v_perm_b32 v122, v55, v55, v42
    v_perm_b32 v123, v55, v55, v43
    v_perm_b32 v124, v55, v55, v44
    v_perm_b32 v125, v55, v55, v45
    v_perm_b32 v126, v55, v55, v46
    v_perm_b32 v127, v55, v55, v47
    v_mfma_f32_16x16x32_bf16 v[16:19], v[64:67], v[128:131], 0
    v_mfma_f32_16x16x32_bf16 v[20:23], v[64:67], v[132:135], 0
    v_mfma_f32_16x16x32_bf16 v[16:19], v[68:71], v[136:139], v[16:19]
    v_mfma_f32_16x16x32_bf16 v[20:23], v[68:71], v[140:143], v[20:23]
    v_mfma_f32_16x16x32_bf16 v[16:19], v[72:75], v[144:147], v[16:19]
    v_mfma_f32_16x16x32_bf16 v[20:23], v[72:75], v[148:151], v[20:23]
    v_mfma_f32_16x16x32_bf16 v[16:19], v[76:79], v[152:155], v[16:19]
    v_mfma_f32_16x16x32_bf16 v[20:23], v[76:79], v[156:159], v[20:23]
    v_mfma_f32_16x16x32_bf16 v[16:19], v[80:83], v[160:163], v[16:19]
    v_mfma_f32_16x16x32_bf16 v[20:23], v[80:83], v[164:167], v[20:23]
    v_mfma_f32_16x16x32_bf16 v[16:19], v[84:87], v[168:171], v[16:19]
    v_mfma_f32_16x16x32_bf16 v[20:23], v[84:87], v[172:175], v[20:23]
    v_mfma_f32_16x16x32_bf16 v[16:19], v[88:91], v[176:179], v[16:19]
    v_mfma_f32_16x16x32_bf16 v[20:23], v[88:91], v[180:183], v[20:23]
    v_mfma_f32_16x16x32_bf16 v[16:19], v[92:95], v[184:187], v[16:19]
    v_mfma_f32_16x16x32_bf16 v[20:23], v[92:95], v[188:191], v[20:23]
    v_mfma_f32_16x16x32_bf16 v[16:19], v[96:99], v[192:195], v[16:19]
    v_mfma_f32_16x16x32_bf16 v[20:23], v[96:99], v[196:199], v[20:23]
    v_mfma_f32_16x16x32_bf16 v[16:19], v[100:103], v[200:203], v[16:19]
    v_mfma_f32_16x16x32_bf16 v[20:23], v[100:103], v[204:207], v[20:23]
    v_mfma_f32_16x16x32_bf16 v[16:19], v[104:107], v[208:211], v[16:19]
    v_mfma_f32_16x16x32_bf16 v[20:23], v[104:107], v[212:215], v[20:23]
    v_mfma_f32_16x16x32_bf16 v[16:19], v[108:111], v[216:219], v[16:19]
    v_mfma_f32_16x16x32_bf16 v[20:23], v[108:111], v[220:223], v[20:23]
    s_setprio 3
    s_waitcnt vmcnt(7)
    s_barrier
    v_mfma_f32_16x16x32_bf16 v[16:19], v[112:115], v[224:227], v[16:19]
    s_waitcnt vmcnt(6)
    v_mfma_f32_16x16x32_bf16 v[20:23], v[112:115], v[228:231], v[20:23]
    s_waitcnt vmcnt(5)
    v_mfma_f32_16x16x32_bf16 v[16:19], v[116:119], v[232:235], v[16:19]
    s_waitcnt vmcnt(4)
    v_mfma_f32_16x16x32_bf16 v[20:23], v[116:119], v[236:239], v[20:23]
    s_waitcnt vmcnt(3)
    v_mfma_f32_16x16x32_bf16 v[16:19], v[120:123], v[240:243], v[16:19]
    s_waitcnt vmcnt(2)
    v_mfma_f32_16x16x32_bf16 v[20:23], v[120:123], v[244:247], v[20:23]
    s_waitcnt vmcnt(1)
    v_mfma_f32_16x16x32_bf16 v[16:19], v[124:127], v[248:251], v[16:19]
    s_waitcnt vmcnt(0)
    v_mfma_f32_16x16x32_bf16 v[20:23], v[124:127], v[252:255], v[20:23]
    s_mov_b32 exec_lo, 0x00ff00ff
    s_mov_b32 exec_hi, 0xff00ff00
    s_nop 3
    ds_write_b128 v12, v[16:19]
    s_nop 0
    ds_write_b128 v12, v[20:23] offset:256
    s_mov_b64 exec, 1
    ds_add_u32 v56, v57 offset:80
    s_mov_b64 exec, -1
    ds_read_b32 v32, v56 offset:80
    ds_read_b128 v[64:67], v5 offset:1024
    ds_read_b128 v[68:71], v5 offset:2048
    ds_read_b128 v[72:75], v5 offset:3072
    ds_read_b128 v[76:79], v5 offset:4096
    s_waitcnt lgkmcnt(4)
    v_cmp_eq_u32 vcc, 4, v32
    s_cmp_eq_u32 s50, 0
    s_cbranch_vccz L_vend
    s_waitcnt lgkmcnt(2)
    v_pk_add_f32 v[64:65], v[64:65], v[68:69]
    v_pk_add_f32 v[66:67], v[66:67], v[70:71]
    s_waitcnt lgkmcnt(0)
    v_pk_add_f32 v[72:73], v[72:73], v[76:77]
    v_pk_add_f32 v[74:75], v[74:75], v[78:79]
    v_pk_add_f32 v[64:65], v[64:65], v[72:73]
    v_pk_add_f32 v[66:67], v[66:67], v[74:75]
    s_cbranch_scc1 L_vthru
    s_nop 0
    v_permlane32_swap_b32 v64, v66
    v_permlane32_swap_b32 v65, v67
    v_pk_add_f32 v[64:65], v[64:65], v[66:67]
    v_bfi_b32 v64, v10, v8, v64
    global_store_dwordx2 v14, v[64:65], s[44:45]
L_vend:
    s_barrier
    s_endpgm
L_requeue:
    s_cmp_lg_u32 s28, 4
    s_cbranch_scc1 L_requeued
    global_store_dwordx2 v14, v[16:17], s[44:45] sc1
    s_waitcnt vmcnt(0)
    s_branch L_requeued
L_vthru:
    s_nop 1
    v_permlane32_swap_b32 v64, v66
    v_permlane32_swap_b32 v65, v67
    v_pk_add_f32 v[64:65], v[64:65], v[66:67]
    v_bfi_b32 v64, v10, v8, v64
    global_store_dwordx2 v14, v[64:65], s[44:45] sc1
    s_branch L_vend
L_exit:
    s_endpgm
L_code_end:
.fill (L_pc+16384-L_code_end)/4, 4, 0xbf810000
.section .rodata,"a"
.p2align 6
.amdhsa_kernel sequential_preLN__sliding_block_cached__swiglu_ffn__decode_kernel
  .amdhsa_next_free_vgpr 256
  .amdhsa_next_free_sgpr 102
  .amdhsa_accum_offset 256
  .amdhsa_group_segment_fixed_size 0
  .amdhsa_kernarg_size 96
  .amdhsa_user_sgpr_count 2
  .amdhsa_user_sgpr_kernarg_segment_ptr 1
  .amdhsa_system_sgpr_workgroup_id_x 1
  .amdhsa_float_denorm_mode_32 3
.end_amdhsa_kernel
```
